```python
import torch

def _softmax(x, axis=-1):
    return torch.softmax(x, dim=axis)
def _gelu(x):
    return torch.nn.functional.gelu(x, approximate="tanh")
def _silu(x):
    return torch.nn.functional.silu(x)
def _sigmoid(x):
    return torch.sigmoid(x)
def _layernorm(x, axis=-1, eps=1e-5):
    m = x.mean(dim=axis, keepdim=True)
    v = x.var(dim=axis, keepdim=True, unbiased=False)
    return (x - m) / torch.sqrt(v + eps)
def _scatter_add(tgt, idx, src, axis=0):
    return tgt.clone().index_add_(axis, idx, src)
def _segment_sum(src, seg, n):
    out = torch.zeros((n,) + src.shape[1:], dtype=src.dtype)
    return out.index_add_(0, seg, src)
def _pad(x, pw):
    flat = tuple(v for pair in reversed(pw) for v in pair)
    return torch.nn.functional.pad(x, flat)

kernel_name = 'sequential_preLN__ssm_conv_s4d__dense_activation_silu__prompt'

def setup_inputs():

    _w = (lambda a: (lambda t: t.to(torch.bfloat16) if t.is_floating_point() else t)(torch.as_tensor(a)))
    def _A_setup():
        Bsz, L, D, N = 1, 2048, 512, 128
        return {
            "u": _w((lambda *s: torch.randn(*s, dtype=torch.bfloat16) * 0.05)(Bsz, L, D)),
            "log_A_real": _w((lambda *s: torch.randn(*s, dtype=torch.bfloat16) * 6.4)(D, N) * 0.5),
            "A_imag": _w((lambda *s: torch.randn(*s, dtype=torch.bfloat16) * 0.05)(D, N) * 3.14),
            "C_real": _w((lambda *s: torch.randn(*s, dtype=torch.bfloat16) * 0.05)(D, N) / N ** 0.5),
            "C_imag": _w((lambda *s: torch.randn(*s, dtype=torch.bfloat16) * 0.05)(D, N) / N ** 0.5),
            "log_dt": _w((lambda *s: torch.randn(*s, dtype=torch.bfloat16) * 0.05)(D) * 0.5 - 4.0),
            "D_skip": _w((lambda *s: torch.randn(*s, dtype=torch.bfloat16) * 0.05)(D)),
        }
    _A_in = _A_setup()

    def _B_setup():
        B, S, D, F = 1, 2048, 512, 1376
        return {
            "x": _w((lambda *s: torch.randn(*s, dtype=torch.bfloat16) * 0.05)(B, S, D)),
            "w1": _w((lambda *s: torch.randn(*s, dtype=torch.bfloat16) * 0.8)(D, F) * (D ** -0.5)),
            "w2": _w((lambda *s: torch.randn(*s, dtype=torch.bfloat16) * 0.2)(F, D) * (F ** -0.5)),
        }
    _B_in = _B_setup()

    return {
        "A_u": _A_in["u"],
        "A_log_A_real": _A_in["log_A_real"],
        "A_A_imag": _A_in["A_imag"],
        "A_C_real": _A_in["C_real"],
        "A_C_imag": _A_in["C_imag"],
        "A_log_dt": _A_in["log_dt"],
        "A_D_skip": _A_in["D_skip"],
        "B_x": _B_in["x"],
        "B_w1": _B_in["w1"],
        "B_w2": _B_in["w2"],
    }

def reference(A_u, A_log_A_real, A_A_imag, A_C_real, A_C_imag, A_log_dt, A_D_skip, B_x, B_w1, B_w2):
    def _A_ref(u, log_A_real, A_imag, C_real, C_imag, log_dt, D_skip):
        L = u.shape[1]
        dt = torch.exp(log_dt)
        A = -torch.exp(log_A_real) + 1j * A_imag
        C = (C_real + 1j * C_imag) * dt[:, None]
        pos = (lambda x, dt: x.to(dt))(torch.arange(L), log_dt.dtype)
        P = torch.exp((A * dt[:, None])[:, :, None] * pos[None, None, :])
        K = 2.0 * torch.einsum("dn,dnl->dl", C, P).real
        L2 = 2 * L
        u_t = (lambda x, *d: x.permute(*d))(u, 0, 2, 1)
        Kf = (lambda x, *a, **k: torch.fft.rfft(x.float(), *a, **k))(K, L2)
        Uf = (lambda x, *a, **k: torch.fft.rfft(x.float(), *a, **k))(u_t, L2)
        y = (lambda x, *a, **k: torch.fft.irfft(x, *a, **k).to(torch.bfloat16))(Uf * Kf[None, :, :], L2)[:, :, :L]
        y = (lambda x, *d: x.permute(*d))(y, 0, 2, 1)
        return y + u * D_skip[None, None, :]

    def _B_ref(x, w1, w2):
        h = torch.einsum("bsd,df->bsf", x, w1)
        h = _silu(h)
        out = torch.einsum("bsf,fd->bsd", h, w2)
        return out

    x = A_u
    h = x + _A_ref(_layernorm(x, axis=-1), A_log_A_real, A_A_imag, A_C_real, A_C_imag, A_log_dt, A_D_skip)
    h2 = h + _B_ref(_layernorm(h, axis=-1), B_w1, B_w2)
    return h2
```

```asm
; @launch grid=(256,1,1) block=(256,1,1) lds=161280
.amdgcn_target "amdgcn-amd-amdhsa--gfx950"
.text
.globl sequential_preLN__ssm_conv_s4d__dense_activation_silu__prompt_kernel
.p2align 8
.type sequential_preLN__ssm_conv_s4d__dense_activation_silu__prompt_kernel,@function
sequential_preLN__ssm_conv_s4d__dense_activation_silu__prompt_kernel:
    s_cmp_ge_u32 s2, 256
    s_cbranch_scc1 L_end
    s_load_dwordx16 s[4:19], s[0:1], 0
    s_load_dwordx4 s[20:23], s[0:1], 64
    s_load_dwordx2 s[24:25], s[0:1], 80
    s_load_dwordx2 s[28:29], s[0:1], 96
    s_getpc_b64 s[98:99]
L_pc:
    s_lshr_b32 s69, s2, 3
    s_lshl_b32 s69, s69, 11
    v_and_b32 v3, 15, v0
    v_lshl_add_u32 v3, v3, 7, s69
    v_min_u32 v3, L_last-L_pc, v3
    global_load_dword v254, v3, s[98:99]
    v_lshrrev_b32 v2, 6, v0
    v_and_b32 v1, 63, v0
    s_and_b32 s52, s2, 7
    v_readfirstlane_b32 s3, v2
    s_lshr_b32 s53, s2, 3
    s_lshl_b32 s54, s52, 5
    s_add_u32 s40, s54, s53
    s_lshl_b32 s54, s40, 9
    v_lshl_add_u32 v29, v0, 1, s54
    s_lshl_b32 s54, s2, 13
    v_and_b32 v3, 31, v0
    v_lshrrev_b32 v28, 5, v0
    v_lshl_add_u32 v3, v3, 4, s54
    v_lshl_add_u32 v28, v28, 10, v3
    s_lshl_b32 s54, s53, 2
    s_add_u32 s55, s54, s3
    s_lshl_b32 s54, s55, 14
    s_lshl_b32 s56, s52, 7
    s_add_u32 s54, s54, s56
    v_lshrrev_b32 v4, 3, v1
    v_xor_b32 v5, v4, v1
    v_and_b32 v5, 7, v5
    v_lshl_add_u32 v5, v5, 4, s54
    v_lshl_add_u32 v31, v4, 11, v5
    s_lshl_b32 s59, s3, 11
    s_add_u32 s59, s59, 135168
    s_mov_b32 m0, s59
    s_lshl_b32 s57, s40, 2
    s_bfe_u32 s54, s2, 0x20004
    s_lshl2_add_u32 s54, s52, s54
    s_lshl_b32 s54, s54, 16
    s_lshr_b32 s56, s2, 6
    s_lshl_b32 s56, s56, 14
    s_add_u32 s54, s54, s56
    s_and_b32 s56, s53, 1
    s_lshl_b32 s56, s56, 13
    s_add_u32 s54, s54, s56
    s_add_u32 s54, s54, 0x401000
    v_lshl_add_u32 v149, v0, 4, s54
    v_mov_b32 v152, -1
    v_mov_b32 v153, -1
    v_mov_b32 v154, -1
    v_mov_b32 v155, -1
    s_waitcnt lgkmcnt(0)
    global_load_ushort v24, v29, s[6:7] nt
    global_load_ushort v25, v29, s[8:9] nt
    global_load_ushort v26, v29, s[10:11] nt
    global_load_ushort v27, v29, s[12:13] nt
    global_load_dwordx4 v[16:19], v28, s[4:5] nt
    global_load_dwordx4 v[20:23], v28, s[4:5] offset:512 nt
    global_load_lds_dwordx4 v31, s[4:5] offset:0 nt
    global_load_lds_dwordx4 v31, s[4:5] offset:1024 nt
    global_store_dwordx4 v149, v[152:155], s[28:29] offset:-4096 sc1
    global_store_dwordx4 v149, v[152:155], s[28:29] offset:0 sc1
    s_load_dword s44, s[28:29], 0
    s_load_dword s45, s[14:15], s57
    s_load_dword s46, s[16:17], s57
    s_lshl1_add_u32 s60, s2, s3
    s_cmp_lt_u32 s60, 352
    s_cselect_b32 s60, s60, 1000
    s_sub_u32 s61, 255, s2
    s_lshl1_add_u32 s61, s61, s3
    s_add_u32 s61, s61, 350
    s_cmp_lt_u32 s3, 2
    s_cselect_b32 s60, s60, s61
    s_lshl_b32 s30, s60, 5
    s_add_u32 s30, s30, 0x5000
    s_cmp_lt_u32 s60, 704
    s_cselect_b32 s30, s30, 0x40000000
    s_cmp_ge_u32 s60, 352
    s_cbranch_scc1 L_task2
    s_lshr_b32 s61, s60, 4
    s_and_b32 s62, s60, 15
    s_mul_i32 s70, s62, 88064
    s_lshl_b32 s63, s61, 7
    s_add_u32 s70, s70, s63
    s_mov_b32 s71, 22016
    s_mov_b32 s72, 44032
    s_movk_i32 s73, 2752
    s_lshl_b32 s63, s61, 16
    s_lshl_b32 s64, s62, 10
    s_add_u32 s74, s63, s64
    s_add_u32 s74, s74, 0x100000
    s_movk_i32 s75, 16384
    s_mov_b32 s76, 0
    s_mov_b32 s77, 0
    s_mov_b32 s26, 0
    s_lshl_b32 s63, s61, 12
    s_lshl_b32 s64, s62, 6
    s_add_u32 s27, s63, s64
    s_add_u32 s27, s27, 0x60000
    s_lshl_b32 s69, s61, 6
    s_branch L_taskgo
L_task2:
    s_sub_u32 s60, s60, 352
    s_lshr_b32 s61, s60, 3
    s_and_b32 s62, s60, 7
    s_mul_i32 s63, s61, 47
    s_lshr_b32 s63, s63, 9
    s_mul_i32 s64, s63, 11
    s_sub_u32 s64, s61, s64
    s_mul_i32 s65, s64, 11
    s_mul_i32 s66, s63, 3
    s_add_u32 s65, s65, s66
    s_lshl_b32 s66, s63, 1
    s_add_u32 s66, s66, s64
    s_mul_i32 s66, s66, 11
    s_sub_u32 s66, s66, 86
    s_mul_i32 s67, s63, 22
    s_add_u32 s67, s67, 8
    s_cmp_eq_u32 s64, 10
    s_cselect_b32 s66, s67, s66
    s_mov_b32 s67, 49152
    s_cselect_b32 s67, 180224, s67
    s_cmp_lt_u32 s64, 8
    s_cselect_b32 s65, s65, s66
    s_cselect_b32 s71, 8192, s67
    s_movk_i32 s72, 4096
    s_cselect_b32 s72, 16384, s72
    s_cselect_b32 s77, 0, 4
    s_lshl_b32 s70, s65, 14
    s_lshl_b32 s66, s62, 7
    s_add_u32 s70, s70, s66
    s_movk_i32 s73, 1024
    s_mul_i32 s74, s62, 44
    s_add_u32 s74, s74, s61
    s_lshl_b32 s74, s74, 12
    s_add_u32 s74, s74, 0x280000
    s_movk_i32 s75, 1024
    s_mov_b32 s76, 1
    s_and_b32 s26, s63, 3
    s_mov_b32 s27, 0x40000000
    s_mov_b32 s69, 0
    s_cmp_lt_u32 s61, 44
    s_cselect_b32 s70, s70, s27
    s_cselect_b32 s74, s74, s27
    s_cselect_b32 s71, s71, 0x2000
L_taskgo:
    v_lshrrev_b32 v30, 3, v1
    v_lshrrev_b32 v6, 5, v1
    v_mad_u32_u24 v30, v6, s77, v30
    v_bfe_u32 v6, v1, 4, 2
    v_and_b32 v7, 7, v1
    v_lshlrev_b32 v6, 1, v6
    v_xor_b32 v7, v6, v7
    v_mul_u32_u24 v30, s73, v30
    v_lshl_add_u32 v30, v7, 4, v30
    v_lshl_add_u32 v7, v7, 3, s69
    v_mov_b32 v8, 0x40000000
    v_cmp_gt_u32 vcc, 1376, v7
    s_add_u32 s66, s70, s71
    s_add_u32 s67, s70, s72
    v_cndmask_b32 v30, v8, v30, vcc
    s_add_u32 s68, s66, s72
    s_sub_u32 s66, s66, 1024
    s_sub_u32 s67, s67, 2048
    s_sub_u32 s68, s68, 3072
    s_lshl_b32 s65, s3, 12
    s_add_u32 s65, s65, 143360
    s_cmp_eq_u32 s76, 0
    s_cselect_b32 s36, s20, s22
    s_cselect_b32 s37, s21, s23
    s_mov_b32 m0, s65
    s_mov_b32 s38, 1409024
    s_mov_b32 s39, 0x20000
    buffer_load_dwordx4 v30, s[36:39], s70 offen offset:0 nt lds
    buffer_load_dwordx4 v30, s[36:39], s66 offen offset:1024 nt lds
    buffer_load_dwordx4 v30, s[36:39], s67 offen offset:2048 nt lds
    buffer_load_dwordx4 v30, s[36:39], s68 offen offset:3072 nt lds
    s_lshl_b32 s26, s26, 10
    s_or_b32 s73, s74, s26
    s_cmp_lt_u32 s3, 2
    s_cselect_b32 s73, 0x40000000, s73
    s_cselect_b32 s74, s74, 0x40000000
    s_cselect_b32 s26, 0x40000000, s30
    s_cselect_b32 s30, s30, 0x40000000
    s_mov_b32 s48, s28
    s_mov_b32 s49, s29
    s_mov_b32 s50, 0x1800000
    s_mov_b32 s51, 0x20000
    v_lshlrev_b32 v148, 4, v1
    s_mul_i32 s64, s53, 6144
    s_lshl_b32 s61, s3, 10
    s_add_u32 s64, s64, s61
    s_mul_i32 s56, s52, 720896
    s_add_u32 s64, s64, s56
    s_add_u32 s72, s64, 0x680000
    s_lshr_b32 s54, s55, 5
    s_mul_i32 s54, s54, 131072
    s_add_u32 s54, s54, s56
    s_and_b32 s56, s55, 31
    s_lshl_b32 s56, s56, 7
    s_add_u32 s54, s54, s56
    s_add_u32 s77, s54, 0x600000
    v_and_b32 v5, 7, v1
    v_lshlrev_b32 v2, 4, v5
    v_lshl_or_b32 v150, v4, 12, v2
    v_lshrrev_b32 v2, 5, v1
    v_xor_b32 v2, v2, v5
    v_lshlrev_b32 v2, 4, v2
    v_lshl_or_b32 v2, v5, 7, v2
    v_and_b32 v3, 3, v4
    v_lshl_add_u32 v3, v3, 2, s59
    v_add_u32 v156, v2, v3
    v_xor_b32 v157, 32, v156
    v_xor_b32 v158, 64, v156
    v_xor_b32 v159, 96, v156
    v_mov_b32 v163, -1
    v_mov_b32 v167, -1
    v_mov_b32 v171, -1
    v_mov_b32 v175, -1
    s_lshl_b32 s54, s52, 2
    s_lshr_b32 s56, s2, 6
    s_add_u32 s41, s54, s56
    s_and_b32 s42, s53, 7
    s_and_b32 s31, s3, 1
    s_mov_b32 s47, 0x3f803f80
    v_and_b32 v70, 15, v1
    v_lshrrev_b32 v71, 4, v1
    s_lshr_b32 s5, s3, 1
    s_lshl_b32 s6, s31, 8
    v_add_u32 v66, 1, v70
    v_and_b32 v67, 7, v66
    v_lshrrev_b32 v66, 3, v66
    v_add_u32 v66, v66, v71
    v_mul_u32_u24 v68, 4240, v67
    v_lshrrev_b32 v67, 1, v67
    v_lshl_add_u32 v68, v67, 7, v68
    v_lshl_add_u32 v68, v66, 4, v68
    s_mul_i32 s7, s5, 34304
    s_add_u32 s12, s7, s6
    s_add_u32 s12, s12, 66560
    v_add_u32 v2, s12, v68
    s_mul_i32 s12, s5, 4608
    s_add_u32 s12, s12, s6
    s_add_u32 s12, s12, 480
    v_lshlrev_b32 v66, 5, v70
    v_lshl_add_u32 v67, v71, 4, s12
    v_sub_u32 v3, v67, v66
    s_lshl_b32 s12, s5, 2
    v_or_b32 v66, s12, v71
    v_and_b32 v67, 7, v1
    v_xor_b32 v66, v66, v67
    v_lshlrev_b32 v66, 4, v66
    v_lshl_or_b32 v66, v70, 7, v66
    s_lshl_b32 s12, s31, 12
    s_add_u32 s12, s12, 9216
    v_add_u32 v4, s12, v66
    v_lshrrev_b32 v68, 3, v1
    v_xor_b32 v66, v67, v68
    v_lshlrev_b32 v66, 4, v66
    v_lshl_or_b32 v66, v68, 7, v66
    s_lshl_b32 s12, s3, 10
    s_add_u32 s12, s12, 9216
    v_add_u32 v5, s12, v66
    v_and_b32 v66, 3, v1
    v_lshlrev_b32 v66, 4, v66
    v_lshl_or_b32 v66, v68, 6, v66
    s_lshl_b32 s12, s3, 9
    s_add_u32 s12, s12, 135168
    v_add_u32 v6, s12, v66
    v_bfe_u32 v66, v1, 2, 1
    v_mul_u32_u24 v66, 0x202, v66
    v_lshlrev_b32 v66, 16, v66
    v_add_u32 v8, 0x01000c0c, v66
    v_lshlrev_b32 v67, 3, v67
    v_lshl_or_b32 v67, v68, 16, v67
    v_and_b32 v66, 1, v1
    v_lshl_or_b32 v7, v66, 30, v67
    s_lshl_b32 s12, s3, 19
    s_lshl_b32 s13, s40, 6
    s_add_u32 s12, s12, s13
    s_add_u32 s52, s12, 0x400000
    v_sub_u32 v66, 255, v0
    v_lshlrev_b32 v9, 4, v66
    s_mul_i32 s12, s42, 11
    s_mul_i32 s13, s3, 3
    s_add_u32 s12, s12, s13
    s_lshr_b32 s12, s12, 2
    s_lshl_b32 s12, s12, 9
    s_add_u32 s12, s12, 0x5000
    s_mul_i32 s13, s3, 88
    s_add_u32 s13, s13, s42
    s_lshl_b32 s13, s13, 5
    s_add_u32 s13, s13, 0x5c00
    v_min_u32 v66, 42, v1
    v_lshl_add_u32 v66, v66, 8, s13
    v_lshl_add_u32 v67, v1, 5, s12
    v_cmp_gt_u32 vcc, 32, v1
    v_max_u32 v67, 32, v1
    v_min_u32 v67, 42, v67
    v_lshl_add_u32 v226, v67, 8, s13
    s_add_u32 s59, s13, 8192
    v_and_b32 v67, 31, v1
    v_lshl_add_u32 v10, v67, 5, s12
    v_min_u32 v10, 0x7be0, v10
    v_lshlrev_b32 v66, 4, v0
    v_add_u32 v103, 66576, v66
    s_mov_b32 s8, 0x1000
    s_mov_b32 s9, 0x2000
    s_mov_b32 s10, 0x3000
    s_mov_b32 s11, 0x4000
    s_mov_b32 s54, 0x0c0c0400
    s_mov_b32 s55, 0x04000c0c
    s_mov_b32 s56, 200000
    s_movk_i32 s57, 0xff
    s_mov_b32 s58, 0xbf317218
    s_lshl_b32 s12, s3, 12
    s_add_u32 s13, s12, 33792
    v_add_u32 v12, s13, v148
    s_lshl_b32 s13, s41, 16
    s_add_u32 s12, s12, s13
    s_add_u32 s12, s12, 0x400000
    v_add_u32 v11, s12, v148
    v_lshlrev_b32 v66, 3, v70
    v_add_u32 v13, 159744, v66
    v_lshrrev_b32 v66, 2, v70
    v_cmp_eq_u32 vcc, v66, v71
    v_lshlrev_b32 v66, 3, v1
    v_add_u32 v66, 160256, v66
    v_cndmask_b32 v69, v66, v13, vcc
    s_lshr_b32 s12, s42, 1
    s_mul_i32 s12, s12, 11
    s_and_b32 s13, s42, 1
    s_add_u32 s14, s13, 8
    s_cmp_eq_u32 s3, 2
    s_cselect_b32 s14, 10, s14
    s_cselect_b32 s13, s13, s3
    s_add_u32 s12, s12, s14
    s_lshl_b32 s12, s12, 1
    s_add_u32 s12, s12, s13
    s_lshl_b32 s12, s12, 9
    v_lshrrev_b32 v66, 1, v71
    v_lshlrev_b32 v66, 8, v66
    v_lshl_or_b32 v66, v70, 4, v66
    v_add_u32 v66, s12, v66
    v_and_b32 v67, 1, v71
    v_lshl_or_b32 v66, v67, 30, v66
    s_cmp_eq_u32 s3, 3
    s_cselect_b64 vcc, -1, 0
    v_cndmask_b32 v14, v66, v69, vcc
    s_lshl_b32 s12, s41, 14
    s_lshl_b32 s13, s42, 7
    s_add_u32 s12, s12, s13
    s_lshl_b32 s13, s3, 5
    s_add_u32 s12, s12, s13
    v_lshl_add_u32 v66, v71, 3, s12
    v_lshl_add_u32 v15, v70, 10, v66
    s_mov_b32 s60, 33792
    s_mul_i32 s12, s3, 11
    s_add_u32 s13, s12, s42
    s_lshl_b32 s61, s13, 10
    s_mul_i32 s13, s42, 44
    s_add_u32 s13, s13, s12
    s_lshl_b32 s13, s13, 12
    s_add_u32 s62, s13, 0x281000
    s_lshr_b32 s13, s41, 2
    s_mul_i32 s13, s13, 540672
    s_mul_i32 s14, s41, 45056
    s_add_u32 s13, s13, s14
    s_add_u32 s53, s13, 0x600000
    s_lshl_b32 s12, s12, 10
    s_add_u32 s12, s12, s53
    s_add_u32 s63, s12, 4096
    s_mul_i32 s12, s3, 3072
    s_add_u32 s64, s12, 0
    s_xor_b32 s12, s3, 1
    s_mul_i32 s12, s12, 3072
    s_add_u32 s65, s12, 0
    s_xor_b32 s12, s3, 2
    s_mul_i32 s12, s12, 3072
    s_add_u32 s66, s12, 1024
    s_xor_b32 s12, s3, 3
    s_mul_i32 s12, s12, 3072
    s_add_u32 s67, s12, 2048
    s_lshl_b32 s12, s42, 11
    s_lshl_b32 s13, s3, 9
    s_add_u32 s12, s12, s13
    s_add_u32 s68, s12, 33792
    v_bfe_u32 v66, v1, 3, 2
    v_and_b32 v67, 3, v1
    v_lshlrev_b32 v67, 3, v67
    v_lshl_or_b32 v66, v66, 5, v67
    v_lshrrev_b32 v69, 2, v1
    v_lshl_or_b32 v66, v69, 7, v66
    s_lshl_b32 s12, s3, 12
    s_add_u32 s12, s12, 143360
    v_add_u32 v144, s12, v66
    v_xor_b32 v145, 32, v144
    v_xor_b32 v146, 64, v144
    v_xor_b32 v147, 96, v144
    v_lshlrev_b32 v66, 4, v71
    v_lshl_or_b32 v66, v70, 10, v66
    v_cmp_gt_u32 vcc, 4, v70
    v_mov_b32 v67, 0x40000000
    v_lshrrev_b32 v68, 5, v1
    v_cndmask_b32 v105, v67, v66, vcc
    v_lshlrev_b32 v109, 3, v68
    s_cmp_eq_u32 s31, 0
    s_mov_b32 s12, 0x76543210
    s_cselect_b32 s12, s12, 0x44433333
    s_mov_b32 s13, 0xcbaaa988
    s_cselect_b32 s13, s13, 0x66655555
    s_mov_b32 s14, 0xffeeeddd
    s_cselect_b32 s14, s14, 0x88877777
    s_mov_b32 s15, 0x22111000
    s_cselect_b32 s15, s15, 0xaaa99999
    s_cselect_b32 s16, 24, 0
    v_and_b32 v66, 31, v1
    v_bfe_u32 v67, v1, 3, 2
    v_mov_b32 v69, s12
    v_cmp_eq_u32 vcc, 1, v67
    v_mov_b32 v72, s13
    s_nop 0
    v_cndmask_b32 v69, v69, v72, vcc
    v_cmp_eq_u32 vcc, 2, v67
    v_mov_b32 v72, s14
    s_nop 0
    v_cndmask_b32 v69, v69, v72, vcc
    v_cmp_eq_u32 vcc, 3, v67
    v_mov_b32 v72, s15
    s_nop 0
    v_cndmask_b32 v69, v69, v72, vcc
    v_and_b32 v72, 7, v1
    v_lshlrev_b32 v72, 2, v72
    v_bfe_u32 v69, v69, v72, 4
    v_cmp_le_u32 vcc, s16, v66
    v_add_u32 v72, 16, v69
    s_mul_i32 s6, s5, 31152
    v_cndmask_b32 v69, v69, v72, vcc
    v_lshl_add_u32 v67, v68, 4, s6
    s_movk_i32 s12, 528
    v_mad_u32_u24 v100, v69, s12, v67
    v_mad_u32_u24 v101, v66, s12, v67
    s_lshl_b32 s12, s31, 8
    s_add_u32 s6, s6, s12
    v_lshlrev_b32 v67, 4, v66
    v_lshl_add_u32 v67, v68, 3, v67
    s_lshl_b32 s12, s31, 11
    s_add_u32 s12, s12, s7
    s_add_u32 s12, s12, 66592
    v_add_u32 v102, s12, v67
    v_and_b32 v66, v66, v68
    v_and_b32 v66, s31, v66
    v_cmp_eq_u32 s[20:21], 1, v66
    v_and_b32 v66, 7, v1
    v_lshrrev_b32 v67, 1, v66
    v_mul_u32_u24 v66, 4240, v66
    v_lshl_add_u32 v66, v67, 7, v66
    v_bfe_u32 v67, v1, 3, 1
    v_mul_u32_u24 v67, 34304, v67
    v_add_u32 v66, v66, v67
    v_add_u32 v66, 66560, v66
    v_mov_b32 v72, 0
    v_mov_b32 v73, 0
    v_mov_b32 v74, 0
    v_mov_b32 v75, 0
    ds_write_b128 v66, v[72:75]
    ds_write_b128 v66, v[72:75] offset:16
    v_mov_b32 v28, v70
    v_mov_b32 v29, s47
    v_cmp_eq_u32 vcc, 0, v28
    s_nop 1
    v_cndmask_b32 v176, 0, v29, vcc
    v_cndmask_b32 v177, 0, v29, vcc
    v_cndmask_b32 v178, 0, v29, vcc
    v_cndmask_b32 v179, 0, v29, vcc
    v_cmp_eq_u32 vcc, 1, v28
    s_nop 1
    v_cndmask_b32 v180, 0, v29, vcc
    v_cndmask_b32 v181, 0, v29, vcc
    v_cndmask_b32 v182, 0, v29, vcc
    v_cndmask_b32 v183, 0, v29, vcc
    v_cmp_eq_u32 vcc, 2, v28
    s_nop 1
    v_cndmask_b32 v184, 0, v29, vcc
    v_cndmask_b32 v185, 0, v29, vcc
    v_cndmask_b32 v186, 0, v29, vcc
    v_cndmask_b32 v187, 0, v29, vcc
    v_cmp_eq_u32 vcc, 3, v28
    s_nop 1
    v_cndmask_b32 v188, 0, v29, vcc
    v_cndmask_b32 v189, 0, v29, vcc
    v_cndmask_b32 v190, 0, v29, vcc
    v_cndmask_b32 v191, 0, v29, vcc
    v_mov_b32 v28, 0
    v_mov_b32 v29, 0
    s_lshl_b32 s12, s2, 6
    s_lshl_b32 s13, s3, 4
    s_add_u32 s12, s12, s13
    s_add_u32 s12, s12, 0x1000
    s_mov_b32 s13, 0x3b000000
    s_waitcnt vmcnt(9)
    v_dot2c_f32_bf16 v28, s47, v16
    v_dot2c_f32_bf16 v29, v16, v16
    v_dot2c_f32_bf16 v28, s47, v17
    v_dot2c_f32_bf16 v29, v17, v17
    v_dot2c_f32_bf16 v28, s47, v18
    v_dot2c_f32_bf16 v29, v18, v18
    v_dot2c_f32_bf16 v28, s47, v19
    v_dot2c_f32_bf16 v29, v19, v19
    s_waitcnt vmcnt(8)
    v_dot2c_f32_bf16 v28, s47, v20
    v_dot2c_f32_bf16 v29, v20, v20
    v_dot2c_f32_bf16 v28, s47, v21
    v_dot2c_f32_bf16 v29, v21, v21
    v_dot2c_f32_bf16 v28, s47, v22
    v_dot2c_f32_bf16 v29, v22, v22
    v_dot2c_f32_bf16 v28, s47, v23
    v_dot2c_f32_bf16 v29, v23, v23
    s_waitcnt lgkmcnt(0)
    s_mul_i32 s43, s44, 0x01010101
    s_add_u32 s43, s43, 0x9e3779b9
    s_waitcnt vmcnt(6)
    ds_read2st64_b32 v[160:161], v156 offset1:4
    ds_read2st64_b32 v[164:165], v157 offset1:4
    ds_read2st64_b32 v[168:169], v158 offset1:4
    ds_read2st64_b32 v[172:173], v159 offset1:4
    v_add_f32 v28, v28, v28 quad_perm:[1,0,3,2] row_mask:0xf bank_mask:0xf
    v_add_f32 v29, v29, v29 quad_perm:[1,0,3,2] row_mask:0xf bank_mask:0xf
    s_nop 0
    v_add_f32 v28, v28, v28 quad_perm:[2,3,0,1] row_mask:0xf bank_mask:0xf
    v_add_f32 v29, v29, v29 quad_perm:[2,3,0,1] row_mask:0xf bank_mask:0xf
    s_nop 0
    v_add_f32 v28, v28, v28 row_half_mirror row_mask:0xf bank_mask:0xf
    v_add_f32 v29, v29, v29 row_half_mirror row_mask:0xf bank_mask:0xf
    s_nop 0
    v_add_f32 v28, v28, v28 row_mirror row_mask:0xf bank_mask:0xf
    v_add_f32 v29, v29, v29 row_mirror row_mask:0xf bank_mask:0xf
    v_mov_b32 v30, v28
    v_mov_b32 v32, v29
    v_lshrrev_b32 v36, v109, s43
    v_permlane16_swap_b32 v28, v30
    v_permlane16_swap_b32 v29, v32
    v_add_f32 v28, v28, v30
    v_add_f32 v29, v29, v32
    v_mul_f32 v28, 0xbb000000, v28
    v_mul_f32 v30, v28, v28
    v_fma_f32 v29, v29, s13, -v30
    v_max_f32 v29, 0, v29
    v_add_f32 v29, 0x3727c5ac, v29
    v_rsq_f32 v29, v29
    v_lshrrev_b32 v37, 16, v36
    v_mul_f32 v28, v28, v29
    v_bfi_b32 v32, s57, v36, v29
    v_bfi_b32 v33, s57, v36, v29
    v_bfi_b32 v34, s57, v37, v28
    v_bfi_b32 v35, s57, v37, v28
    v_permlane32_swap_b32 v32, v33
    s_nop 0
    v_permlane32_swap_b32 v34, v35
    v_mov_b32 v162, s43
    v_mov_b32 v166, s43
    v_mov_b32 v170, s43
    v_mov_b32 v174, s43
    s_waitcnt vmcnt(4)
    s_mov_b64 exec, 1
    buffer_store_dwordx4 v[32:35], off, s[48:51], s12 sc1
    s_mov_b64 exec, -1
    s_waitcnt lgkmcnt(3)
    buffer_store_dwordx4 v[160:163], v150, s[48:51], s77 offen sc1
    s_add_u32 s77, s77, 0x8000
    s_waitcnt lgkmcnt(2)
    buffer_store_dwordx4 v[164:167], v150, s[48:51], s77 offen sc1
    s_add_u32 s77, s77, 0x8000
    s_waitcnt lgkmcnt(1)
    buffer_store_dwordx4 v[168:171], v150, s[48:51], s77 offen sc1
    s_add_u32 s77, s77, 0x8000
    s_waitcnt lgkmcnt(0)
    buffer_store_dwordx4 v[172:175], v150, s[48:51], s77 offen sc1
    s_lshl_b32 s12, s5, 4
    s_lshr_b32 s13, s46, s12
    s_lshl_b32 s13, s13, 16
    s_cmp_eq_u32 s31, 0
    s_cselect_b32 s13, s13, 0
    v_mov_b32 v111, 0
    s_lshr_b32 s12, s45, s12
    s_lshl_b32 s12, s12, 16
    v_writelane_b32 v111, s13, 0
    v_mov_b32 v16, 0x3fb8aa3b
    v_mul_f32 v17, s12, v16
    v_lshlrev_b32 v24, 16, v24
    v_exp_f32 v17, v17
    v_mul_f32 v24, v16, v24
    v_lshlrev_b32 v25, 16, v25
    v_exp_f32 v24, v24
    v_lshlrev_b32 v26, 16, v26
    v_lshlrev_b32 v27, 16, v27
    v_cvt_pk_bf16_f32 v17, v17, v17
    v_and_b32 v17, 0xffff0000, v17
    v_cvt_pk_bf16_f32 v24, v24, v24
    v_and_b32 v24, 0xffff0000, v24
    v_mul_f32 v24, v24, v17
    v_mul_f32 v25, v25, v17
    v_add_f32 v17, v17, v17
    v_mul_f32 v24, 0xbfb8aa3b, v24
    v_mul_f32 v25, 0x3e22f983, v25
    v_mul_f32 v44, v26, v17
    v_mul_f32 v45, v27, v17
    v_exp_f32 v18, v24
    v_fract_f32 v19, v25
    v_cos_f32 v36, v19
    v_sin_f32 v37, v19
    s_nop 0
    v_pk_mul_f32 v[36:37], v[36:37], v[18:19] op_sel_hi:[1,0]
    v_mul_f32 v18, 0x41000000, v24
    v_mul_f32 v19, 0x41000000, v25
    v_exp_f32 v18, v18
    v_fract_f32 v19, v19
    v_cos_f32 v38, v19
    v_sin_f32 v39, v19
    s_nop 0
    v_pk_mul_f32 v[38:39], v[38:39], v[18:19] op_sel_hi:[1,0] neg_hi:[1,0]
    v_mul_f32 v18, 0x43800000, v24
    v_mul_f32 v19, 0x43800000, v25
    v_exp_f32 v18, v18
    v_fract_f32 v19, v19
    v_cos_f32 v40, v19
    v_sin_f32 v41, v19
    s_nop 0
    v_pk_mul_f32 v[40:41], v[40:41], v[18:19] op_sel_hi:[1,0]
    s_mov_b32 m0, s6
    v_mov_b32 v16, 0x3f80
    ds_write_addtid_b32 v16 offset:14256
    v_cvt_pk_bf16_f32 v20, v44, v45
    v_cvt_pk_bf16_f32 v21, v38, v39
    ds_write_addtid_b32 v20 offset:0
    ds_write_addtid_b32 v21 offset:14784
    s_waitcnt lgkmcnt(0)
    s_waitcnt vmcnt(5)
    ds_read_b64_tr_b16 v[192:193], v144 offset:0
    ds_read_b64_tr_b16 v[194:195], v144 offset:2048
    ds_read_b64_tr_b16 v[196:197], v145 offset:0
    ds_read_b64_tr_b16 v[198:199], v145 offset:2048
    ds_read_b64_tr_b16 v[200:201], v146 offset:0
    ds_read_b64_tr_b16 v[202:203], v146 offset:2048
    ds_read_b64_tr_b16 v[204:205], v147 offset:0
    ds_read_b64_tr_b16 v[206:207], v147 offset:2048
    v_pk_mul_f32 v[46:47], v[44:45], v[36:37] op_sel_hi:[1,0]
    v_pk_fma_f32 v[46:47], v[44:45], v[36:37], v[46:47] op_sel:[1,1,0] op_sel_hi:[0,1,1] neg_lo:[0,1,0]
    v_pk_mul_f32 v[62:63], v[38:39], v[38:39] op_sel_hi:[1,0]
    v_pk_fma_f32 v[62:63], v[38:39], v[38:39], v[62:63] op_sel:[1,1,0] op_sel_hi:[0,1,1] neg_lo:[0,1,0]
    v_cvt_pk_bf16_f32 v22, v46, v47
    v_cvt_pk_bf16_f32 v23, v62, v63
    v_pk_mul_f32 v[48:49], v[46:47], v[36:37] op_sel_hi:[1,0]
    v_pk_fma_f32 v[48:49], v[46:47], v[36:37], v[48:49] op_sel:[1,1,0] op_sel_hi:[0,1,1] neg_lo:[0,1,0]
    v_pk_mul_f32 v[64:65], v[62:63], v[38:39] op_sel_hi:[1,0]
    v_pk_fma_f32 v[64:65], v[62:63], v[38:39], v[64:65] op_sel:[1,1,0] op_sel_hi:[0,1,1] neg_lo:[0,1,0]
    v_cvt_pk_bf16_f32 v28, v48, v49
    s_waitcnt lgkmcnt(0)
    buffer_store_dwordx4 v[192:195], v148, s[48:51], s74 offen sc1
    v_mfma_f32_16x16x32_bf16 v[208:211], v[192:195], v[176:179], 0
    s_add_u32 s74, s74, s75
    buffer_store_dwordx4 v[196:199], v148, s[48:51], s74 offen sc1
    v_mfma_f32_16x16x32_bf16 v[208:211], v[196:199], v[180:183], v[208:211]
    s_add_u32 s74, s74, s75
    buffer_store_dwordx4 v[200:203], v148, s[48:51], s74 offen sc1
    v_mfma_f32_16x16x32_bf16 v[208:211], v[200:203], v[184:187], v[208:211]
    s_add_u32 s74, s74, s75
    buffer_store_dwordx4 v[204:207], v148, s[48:51], s74 offen sc1
    v_mfma_f32_16x16x32_bf16 v[208:211], v[204:207], v[188:191], v[208:211]
    v_cvt_pk_bf16_f32 v29, v64, v65
    ds_write_addtid_b32 v22 offset:528
    ds_write_addtid_b32 v23 offset:15312
    ds_write_addtid_b32 v28 offset:1056
    ds_write_addtid_b32 v29 offset:15840
    v_pk_mul_f32 v[50:51], v[48:49], v[36:37] op_sel_hi:[1,0]
    v_pk_fma_f32 v[50:51], v[48:49], v[36:37], v[50:51] op_sel:[1,1,0] op_sel_hi:[0,1,1] neg_lo:[0,1,0]
    v_pk_mul_f32 v[62:63], v[64:65], v[38:39] op_sel_hi:[1,0]
    v_pk_fma_f32 v[62:63], v[64:65], v[38:39], v[62:63] op_sel:[1,1,0] op_sel_hi:[0,1,1] neg_lo:[0,1,0]
    v_cvt_pk_bf16_f32 v30, v50, v51
    buffer_store_dwordx4 v[208:211], v105, s[48:51], s27 offen sc1
    v_cvt_pk_bf16_f32 v31, v62, v63
    v_pk_mul_f32 v[52:53], v[50:51], v[36:37] op_sel_hi:[1,0]
    v_pk_fma_f32 v[52:53], v[50:51], v[36:37], v[52:53] op_sel:[1,1,0] op_sel_hi:[0,1,1] neg_lo:[0,1,0]
    v_pk_mul_f32 v[64:65], v[62:63], v[38:39] op_sel_hi:[1,0]
    v_pk_fma_f32 v[64:65], v[62:63], v[38:39], v[64:65] op_sel:[1,1,0] op_sel_hi:[0,1,1] neg_lo:[0,1,0]
    v_cvt_pk_bf16_f32 v20, v52, v53
    v_cvt_pk_bf16_f32 v21, v64, v65
    ds_write_addtid_b32 v30 offset:1584
    ds_write_addtid_b32 v31 offset:16368
    ds_write_addtid_b32 v20 offset:2112
    ds_write_addtid_b32 v21 offset:16896
    v_pk_mul_f32 v[54:55], v[52:53], v[36:37] op_sel_hi:[1,0]
    v_pk_fma_f32 v[54:55], v[52:53], v[36:37], v[54:55] op_sel:[1,1,0] op_sel_hi:[0,1,1] neg_lo:[0,1,0]
    v_pk_mul_f32 v[62:63], v[64:65], v[38:39] op_sel_hi:[1,0]
    v_pk_fma_f32 v[62:63], v[64:65], v[38:39], v[62:63] op_sel:[1,1,0] op_sel_hi:[0,1,1] neg_lo:[0,1,0]
    v_cvt_pk_bf16_f32 v22, v54, v55
    v_cvt_pk_bf16_f32 v23, v62, v63
    v_pk_mul_f32 v[56:57], v[54:55], v[36:37] op_sel_hi:[1,0]
    v_pk_fma_f32 v[56:57], v[54:55], v[36:37], v[56:57] op_sel:[1,1,0] op_sel_hi:[0,1,1] neg_lo:[0,1,0]
    v_pk_mul_f32 v[64:65], v[62:63], v[38:39] op_sel_hi:[1,0]
    v_pk_fma_f32 v[64:65], v[62:63], v[38:39], v[64:65] op_sel:[1,1,0] op_sel_hi:[0,1,1] neg_lo:[0,1,0]
    v_cvt_pk_bf16_f32 v28, v56, v57
    v_cvt_pk_bf16_f32 v29, v64, v65
    ds_write_addtid_b32 v22 offset:2640
    ds_write_addtid_b32 v23 offset:17424
    ds_write_addtid_b32 v28 offset:3168
    ds_write_addtid_b32 v29 offset:17952
    v_pk_mul_f32 v[58:59], v[56:57], v[36:37] op_sel_hi:[1,0]
    v_pk_fma_f32 v[58:59], v[56:57], v[36:37], v[58:59] op_sel:[1,1,0] op_sel_hi:[0,1,1] neg_lo:[0,1,0]
    v_pk_mul_f32 v[62:63], v[64:65], v[38:39] op_sel_hi:[1,0]
    v_pk_fma_f32 v[62:63], v[64:65], v[38:39], v[62:63] op_sel:[1,1,0] op_sel_hi:[0,1,1] neg_lo:[0,1,0]
    v_cvt_pk_bf16_f32 v30, v58, v59
    v_cvt_pk_bf16_f32 v31, v62, v63
    v_pk_mul_f32 v[60:61], v[58:59], v[36:37] op_sel_hi:[1,0]
    v_pk_fma_f32 v[60:61], v[58:59], v[36:37], v[60:61] op_sel:[1,1,0] op_sel_hi:[0,1,1] neg_lo:[0,1,0]
    v_pk_mul_f32 v[64:65], v[62:63], v[38:39] op_sel_hi:[1,0]
    v_pk_fma_f32 v[64:65], v[62:63], v[38:39], v[64:65] op_sel:[1,1,0] op_sel_hi:[0,1,1] neg_lo:[0,1,0]
    v_pk_mul_f32 v[76:77], v[44:45], v[40:41] op_sel_hi:[1,0]
    v_pk_fma_f32 v[76:77], v[44:45], v[40:41], v[76:77] op_sel:[1,1,0] op_sel_hi:[0,1,1] neg_lo:[0,1,0]
    v_cvt_pk_bf16_f32 v20, v64, v65
    v_cvt_pk_bf16_f32 v21, v76, v77
    ds_write_addtid_b32 v30 offset:3696
    ds_write_addtid_b32 v31 offset:18480
    ds_write_addtid_b32 v20 offset:19008
    ds_write_addtid_b32 v21 offset:4224
    v_pk_mul_f32 v[62:63], v[64:65], v[38:39] op_sel_hi:[1,0]
    v_pk_fma_f32 v[62:63], v[64:65], v[38:39], v[62:63] op_sel:[1,1,0] op_sel_hi:[0,1,1] neg_lo:[0,1,0]
    v_pk_mul_f32 v[80:81], v[48:49], v[40:41] op_sel_hi:[1,0]
    v_pk_fma_f32 v[80:81], v[48:49], v[40:41], v[80:81] op_sel:[1,1,0] op_sel_hi:[0,1,1] neg_lo:[0,1,0]
    v_cvt_pk_bf16_f32 v22, v62, v63
    v_cvt_pk_bf16_f32 v23, v80, v81
    v_pk_mul_f32 v[64:65], v[62:63], v[38:39] op_sel_hi:[1,0]
    v_pk_fma_f32 v[64:65], v[62:63], v[38:39], v[64:65] op_sel:[1,1,0] op_sel_hi:[0,1,1] neg_lo:[0,1,0]
    v_pk_mul_f32 v[84:85], v[52:53], v[40:41] op_sel_hi:[1,0]
    v_pk_fma_f32 v[84:85], v[52:53], v[40:41], v[84:85] op_sel:[1,1,0] op_sel_hi:[0,1,1] neg_lo:[0,1,0]
    v_cvt_pk_bf16_f32 v28, v64, v65
    v_cvt_pk_bf16_f32 v29, v84, v85
    ds_write_addtid_b32 v22 offset:19536
    ds_write_addtid_b32 v23 offset:4752
    ds_write_addtid_b32 v28 offset:20064
    ds_write_addtid_b32 v29 offset:5280
    v_pk_mul_f32 v[62:63], v[64:65], v[38:39] op_sel_hi:[1,0]
    v_pk_fma_f32 v[62:63], v[64:65], v[38:39], v[62:63] op_sel:[1,1,0] op_sel_hi:[0,1,1] neg_lo:[0,1,0]
    v_pk_mul_f32 v[88:89], v[56:57], v[40:41] op_sel_hi:[1,0]
    v_pk_fma_f32 v[88:89], v[56:57], v[40:41], v[88:89] op_sel:[1,1,0] op_sel_hi:[0,1,1] neg_lo:[0,1,0]
    v_cvt_pk_bf16_f32 v30, v62, v63
    v_cvt_pk_bf16_f32 v31, v88, v89
    v_pk_mul_f32 v[64:65], v[62:63], v[38:39] op_sel_hi:[1,0]
    v_pk_fma_f32 v[64:65], v[62:63], v[38:39], v[64:65] op_sel:[1,1,0] op_sel_hi:[0,1,1] neg_lo:[0,1,0]
    v_pk_mul_f32 v[92:93], v[60:61], v[40:41] op_sel_hi:[1,0]
    v_pk_fma_f32 v[92:93], v[60:61], v[40:41], v[92:93] op_sel:[1,1,0] op_sel_hi:[0,1,1] neg_lo:[0,1,0]
    v_cvt_pk_bf16_f32 v20, v64, v65
    v_cvt_pk_bf16_f32 v21, v92, v93
    ds_write_addtid_b32 v30 offset:20592
    ds_write_addtid_b32 v31 offset:5808
    ds_write_addtid_b32 v20 offset:21120
    ds_write_addtid_b32 v21 offset:6336
    v_pk_mul_f32 v[62:63], v[64:65], v[38:39] op_sel_hi:[1,0]
    v_pk_fma_f32 v[62:63], v[64:65], v[38:39], v[62:63] op_sel:[1,1,0] op_sel_hi:[0,1,1] neg_lo:[0,1,0]
    v_pk_mul_f32 v[44:45], v[76:77], v[40:41] op_sel_hi:[1,0]
    v_pk_fma_f32 v[44:45], v[76:77], v[40:41], v[44:45] op_sel:[1,1,0] op_sel_hi:[0,1,1] neg_lo:[0,1,0]
    v_cvt_pk_bf16_f32 v22, v62, v63
    v_cvt_pk_bf16_f32 v23, v44, v45
    v_pk_mul_f32 v[64:65], v[62:63], v[38:39] op_sel_hi:[1,0]
    v_pk_fma_f32 v[64:65], v[62:63], v[38:39], v[64:65] op_sel:[1,1,0] op_sel_hi:[0,1,1] neg_lo:[0,1,0]
    v_pk_mul_f32 v[52:53], v[84:85], v[40:41] op_sel_hi:[1,0]
    v_pk_fma_f32 v[52:53], v[84:85], v[40:41], v[52:53] op_sel:[1,1,0] op_sel_hi:[0,1,1] neg_lo:[0,1,0]
    v_cvt_pk_bf16_f32 v28, v64, v65
    v_cvt_pk_bf16_f32 v29, v52, v53
    ds_write_addtid_b32 v22 offset:21648
    ds_write_addtid_b32 v23 offset:6864
    ds_write_addtid_b32 v28 offset:22176
    ds_write_addtid_b32 v29 offset:7392
    v_pk_mul_f32 v[62:63], v[64:65], v[38:39] op_sel_hi:[1,0]
    v_pk_fma_f32 v[62:63], v[64:65], v[38:39], v[62:63] op_sel:[1,1,0] op_sel_hi:[0,1,1] neg_lo:[0,1,0]
    v_pk_mul_f32 v[60:61], v[92:93], v[40:41] op_sel_hi:[1,0]
    v_pk_fma_f32 v[60:61], v[92:93], v[40:41], v[60:61] op_sel:[1,1,0] op_sel_hi:[0,1,1] neg_lo:[0,1,0]
    v_cvt_pk_bf16_f32 v30, v62, v63
    v_cvt_pk_bf16_f32 v31, v60, v61
    v_pk_mul_f32 v[64:65], v[62:63], v[38:39] op_sel_hi:[1,0]
    v_pk_fma_f32 v[64:65], v[62:63], v[38:39], v[64:65] op_sel:[1,1,0] op_sel_hi:[0,1,1] neg_lo:[0,1,0]
    v_pk_mul_f32 v[76:77], v[44:45], v[40:41] op_sel_hi:[1,0]
    v_pk_fma_f32 v[76:77], v[44:45], v[40:41], v[76:77] op_sel:[1,1,0] op_sel_hi:[0,1,1] neg_lo:[0,1,0]
    v_cvt_pk_bf16_f32 v20, v64, v65
    v_cvt_pk_bf16_f32 v21, v76, v77
    ds_write_addtid_b32 v30 offset:22704
    ds_write_addtid_b32 v31 offset:7920
    ds_write_addtid_b32 v20 offset:23232
    ds_write_addtid_b32 v21 offset:8448
    v_pk_mul_f32 v[62:63], v[64:65], v[38:39] op_sel_hi:[1,0]
    v_pk_fma_f32 v[62:63], v[64:65], v[38:39], v[62:63] op_sel:[1,1,0] op_sel_hi:[0,1,1] neg_lo:[0,1,0]
    v_pk_mul_f32 v[84:85], v[52:53], v[40:41] op_sel_hi:[1,0]
    v_pk_fma_f32 v[84:85], v[52:53], v[40:41], v[84:85] op_sel:[1,1,0] op_sel_hi:[0,1,1] neg_lo:[0,1,0]
    v_cvt_pk_bf16_f32 v22, v62, v63
    v_cvt_pk_bf16_f32 v23, v84, v85
    v_pk_mul_f32 v[64:65], v[62:63], v[38:39] op_sel_hi:[1,0]
    v_pk_fma_f32 v[64:65], v[62:63], v[38:39], v[64:65] op_sel:[1,1,0] op_sel_hi:[0,1,1] neg_lo:[0,1,0]
    v_pk_mul_f32 v[92:93], v[60:61], v[40:41] op_sel_hi:[1,0]
    v_pk_fma_f32 v[92:93], v[60:61], v[40:41], v[92:93] op_sel:[1,1,0] op_sel_hi:[0,1,1] neg_lo:[0,1,0]
    v_cvt_pk_bf16_f32 v28, v64, v65
    v_cvt_pk_bf16_f32 v29, v92, v93
    ds_write_addtid_b32 v22 offset:23760
    ds_write_addtid_b32 v23 offset:8976
    ds_write_addtid_b32 v28 offset:24288
    ds_write_addtid_b32 v29 offset:9504
    v_pk_mul_f32 v[62:63], v[64:65], v[38:39] op_sel_hi:[1,0]
    v_pk_fma_f32 v[62:63], v[64:65], v[38:39], v[62:63] op_sel:[1,1,0] op_sel_hi:[0,1,1] neg_lo:[0,1,0]
    v_pk_mul_f32 v[44:45], v[76:77], v[40:41] op_sel_hi:[1,0]
    v_pk_fma_f32 v[44:45], v[76:77], v[40:41], v[44:45] op_sel:[1,1,0] op_sel_hi:[0,1,1] neg_lo:[0,1,0]
    v_cvt_pk_bf16_f32 v30, v62, v63
    v_cvt_pk_bf16_f32 v31, v44, v45
    v_pk_mul_f32 v[64:65], v[62:63], v[38:39] op_sel_hi:[1,0]
    v_pk_fma_f32 v[64:65], v[62:63], v[38:39], v[64:65] op_sel:[1,1,0] op_sel_hi:[0,1,1] neg_lo:[0,1,0]
    v_pk_mul_f32 v[60:61], v[92:93], v[40:41] op_sel_hi:[1,0]
    v_pk_fma_f32 v[60:61], v[92:93], v[40:41], v[60:61] op_sel:[1,1,0] op_sel_hi:[0,1,1] neg_lo:[0,1,0]
    v_cvt_pk_bf16_f32 v20, v64, v65
    v_cvt_pk_bf16_f32 v21, v60, v61
    ds_write_addtid_b32 v30 offset:24816
    ds_write_addtid_b32 v31 offset:10032
    ds_write_addtid_b32 v20 offset:25344
    ds_write_addtid_b32 v21 offset:10560
    v_pk_mul_f32 v[62:63], v[64:65], v[38:39] op_sel_hi:[1,0]
    v_pk_fma_f32 v[62:63], v[64:65], v[38:39], v[62:63] op_sel:[1,1,0] op_sel_hi:[0,1,1] neg_lo:[0,1,0]
    v_pk_mul_f32 v[76:77], v[44:45], v[40:41] op_sel_hi:[1,0]
    v_pk_fma_f32 v[76:77], v[44:45], v[40:41], v[76:77] op_sel:[1,1,0] op_sel_hi:[0,1,1] neg_lo:[0,1,0]
    v_cvt_pk_bf16_f32 v22, v62, v63
    v_cvt_pk_bf16_f32 v23, v76, v77
    v_pk_mul_f32 v[64:65], v[62:63], v[38:39] op_sel_hi:[1,0]
    v_pk_fma_f32 v[64:65], v[62:63], v[38:39], v[64:65] op_sel:[1,1,0] op_sel_hi:[0,1,1] neg_lo:[0,1,0]
    v_pk_mul_f32 v[92:93], v[60:61], v[40:41] op_sel_hi:[1,0]
    v_pk_fma_f32 v[92:93], v[60:61], v[40:41], v[92:93] op_sel:[1,1,0] op_sel_hi:[0,1,1] neg_lo:[0,1,0]
    v_cvt_pk_bf16_f32 v28, v64, v65
    v_cvt_pk_bf16_f32 v29, v92, v93
    ds_write_addtid_b32 v22 offset:25872
    ds_write_addtid_b32 v23 offset:11088
    ds_write_addtid_b32 v28 offset:26400
    ds_write_addtid_b32 v29 offset:11616
    v_pk_mul_f32 v[62:63], v[64:65], v[38:39] op_sel_hi:[1,0]
    v_pk_fma_f32 v[62:63], v[64:65], v[38:39], v[62:63] op_sel:[1,1,0] op_sel_hi:[0,1,1] neg_lo:[0,1,0]
    v_pk_mul_f32 v[44:45], v[76:77], v[40:41] op_sel_hi:[1,0]
    v_pk_fma_f32 v[44:45], v[76:77], v[40:41], v[44:45] op_sel:[1,1,0] op_sel_hi:[0,1,1] neg_lo:[0,1,0]
    v_cvt_pk_bf16_f32 v30, v62, v63
    v_cvt_pk_bf16_f32 v31, v44, v45
    v_mov_b32 v212, s43
    s_waitcnt vmcnt(0)
    s_mov_b64 exec, 1
    buffer_store_dword v212, off, s[48:51], s30 sc1
    s_mov_b64 exec, -1
    v_pk_mul_f32 v[64:65], v[62:63], v[38:39] op_sel_hi:[1,0]
    v_pk_fma_f32 v[64:65], v[62:63], v[38:39], v[64:65] op_sel:[1,1,0] op_sel_hi:[0,1,1] neg_lo:[0,1,0]
    v_pk_mul_f32 v[60:61], v[92:93], v[40:41] op_sel_hi:[1,0]
    v_pk_fma_f32 v[60:61], v[92:93], v[40:41], v[60:61] op_sel:[1,1,0] op_sel_hi:[0,1,1] neg_lo:[0,1,0]
    v_cvt_pk_bf16_f32 v20, v64, v65
    v_cvt_pk_bf16_f32 v21, v60, v61
    ds_write_addtid_b32 v30 offset:26928
    ds_write_addtid_b32 v31 offset:12144
    ds_write_addtid_b32 v20 offset:27456
    ds_write_addtid_b32 v21 offset:12672
    v_pk_mul_f32 v[62:63], v[64:65], v[38:39] op_sel_hi:[1,0]
    v_pk_fma_f32 v[62:63], v[64:65], v[38:39], v[62:63] op_sel:[1,1,0] op_sel_hi:[0,1,1] neg_lo:[0,1,0]
    v_pk_mul_f32 v[76:77], v[44:45], v[40:41] op_sel_hi:[1,0]
    v_pk_fma_f32 v[76:77], v[44:45], v[40:41], v[76:77] op_sel:[1,1,0] op_sel_hi:[0,1,1] neg_lo:[0,1,0]
    v_cvt_pk_bf16_f32 v22, v62, v63
    v_cvt_pk_bf16_f32 v23, v76, v77
    v_pk_mul_f32 v[64:65], v[62:63], v[38:39] op_sel_hi:[1,0]
    v_pk_fma_f32 v[64:65], v[62:63], v[38:39], v[64:65] op_sel:[1,1,0] op_sel_hi:[0,1,1] neg_lo:[0,1,0]
    v_pk_mul_f32 v[92:93], v[60:61], v[40:41] op_sel_hi:[1,0]
    v_pk_fma_f32 v[92:93], v[60:61], v[40:41], v[92:93] op_sel:[1,1,0] op_sel_hi:[0,1,1] neg_lo:[0,1,0]
    v_cvt_pk_bf16_f32 v28, v64, v65
    v_cvt_pk_bf16_f32 v29, v92, v93
    ds_write_addtid_b32 v22 offset:27984
    ds_write_addtid_b32 v23 offset:13200
    ds_write_addtid_b32 v28 offset:28512
    ds_write_addtid_b32 v29 offset:13728
    v_pk_mul_f32 v[62:63], v[64:65], v[38:39] op_sel_hi:[1,0]
    v_pk_fma_f32 v[62:63], v[64:65], v[38:39], v[62:63] op_sel:[1,1,0] op_sel_hi:[0,1,1] neg_lo:[0,1,0]
    v_cvt_pk_bf16_f32 v30, v62, v63
    v_pk_mul_f32 v[64:65], v[62:63], v[38:39] op_sel_hi:[1,0]
    v_pk_fma_f32 v[64:65], v[62:63], v[38:39], v[64:65] op_sel:[1,1,0] op_sel_hi:[0,1,1] neg_lo:[0,1,0]
    v_cvt_pk_bf16_f32 v31, v64, v65
    v_pk_mul_f32 v[62:63], v[64:65], v[38:39] op_sel_hi:[1,0]
    v_pk_fma_f32 v[62:63], v[64:65], v[38:39], v[62:63] op_sel:[1,1,0] op_sel_hi:[0,1,1] neg_lo:[0,1,0]
    v_cvt_pk_bf16_f32 v20, v62, v63
    v_pk_mul_f32 v[64:65], v[62:63], v[38:39] op_sel_hi:[1,0]
    v_pk_fma_f32 v[64:65], v[62:63], v[38:39], v[64:65] op_sel:[1,1,0] op_sel_hi:[0,1,1] neg_lo:[0,1,0]
    v_cvt_pk_bf16_f32 v21, v64, v65
    ds_write_addtid_b32 v30 offset:29040
    ds_write_addtid_b32 v31 offset:29568
    ds_write_addtid_b32 v20 offset:30096
    ds_write_addtid_b32 v21 offset:30624
    s_lshr_b32 s17, s40, 5
    s_mul_i32 s17, s17, 589824
    s_lshl_b32 s16, s40, 12
    s_add_u32 s16, s16, s17
    s_add_u32 s17, s16, 6422528
    s_add_u32 s18, s16, 6553600
    s_add_u32 s19, s16, 6684672
    s_add_u32 s16, s16, 0x600000
    s_waitcnt lgkmcnt(0)
    s_barrier
    ds_read_b128 a[0:3], v100 offset:0
    ds_read_b128 a[64:67], v101 offset:14256
    ds_read_b128 a[4:7], v100 offset:32
    ds_read_b128 a[68:71], v101 offset:14288
    ds_read_b128 a[8:11], v100 offset:64
    ds_read_b128 a[72:75], v101 offset:14320
    ds_read_b128 a[12:15], v100 offset:96
    ds_read_b128 a[76:79], v101 offset:14352
    ds_read_b128 a[16:19], v100 offset:128
    ds_read_b128 a[80:83], v101 offset:14384
    ds_read_b128 a[20:23], v100 offset:160
    ds_read_b128 a[84:87], v101 offset:14416
    ds_read_b128 a[24:27], v100 offset:192
    ds_read_b128 a[88:91], v101 offset:14448
    s_waitcnt lgkmcnt(12)
    v_mfma_f32_32x32x16_bf16 v[16:31], a[0:3], a[64:67], 0
    ds_read_b128 a[28:31], v100 offset:224
    ds_read_b128 a[92:95], v101 offset:14480
    s_mul_i32 s12, s42, 11
    s_mul_i32 s13, s3, 3
    s_add_u32 s12, s12, s13
    s_waitcnt lgkmcnt(12)
    v_mfma_f32_32x32x16_bf16 v[16:31], a[4:7], a[68:71], v[16:31]
    ds_read_b128 a[32:35], v100 offset:256
    ds_read_b128 a[96:99], v101 offset:14512
    s_lshl_b32 s13, s12, 10
    s_add_u32 s13, s13, 0x60000
    v_lshl_add_u32 v38, v1, 2, s13
    s_waitcnt lgkmcnt(12)
    v_mfma_f32_32x32x16_bf16 v[16:31], a[8:11], a[72:75], v[16:31]
    ds_read_b128 a[36:39], v100 offset:288
    ds_read_b128 a[100:103], v101 offset:14544
    s_lshl_b32 s12, s12, 14
    s_bfe_u32 s15, s2, 0x20006
    s_lshl_b32 s32, s15, 12
    s_waitcnt lgkmcnt(12)
    v_mfma_f32_32x32x16_bf16 v[16:31], a[12:15], a[76:79], v[16:31]
    ds_read_b128 a[40:43], v100 offset:320
    ds_read_b128 a[104:107], v101 offset:14576
    s_add_u32 s12, s12, s32
    s_add_u32 s12, s12, 0x100000
    v_add_u32 v32, s12, v148
    s_waitcnt lgkmcnt(12)
    v_mfma_f32_32x32x16_bf16 v[16:31], a[16:19], a[80:83], v[16:31]
    ds_read_b128 a[44:47], v100 offset:352
    ds_read_b128 a[108:111], v101 offset:14608
    v_add_u32 v33, 0x4000, v32
    s_cmp_eq_u32 s3, 3
    s_cselect_b32 s13, 0, 16
    s_add_u32 s12, s12, 32768
    s_waitcnt lgkmcnt(12)
    v_mfma_f32_32x32x16_bf16 v[16:31], a[20:23], a[84:87], v[16:31]
    ds_read_b128 a[48:51], v100 offset:384
    ds_read_b128 a[112:115], v101 offset:14640
    v_mov_b32 v34, s12
    v_mad_u32_u24 v34, v1, s13, v34
    s_xor_b32 s13, s32, 4096
    s_xor_b32 s14, s32, 0
    s_sub_u32 s33, s13, s14
    s_waitcnt lgkmcnt(12)
    v_mfma_f32_32x32x16_bf16 v[16:31], a[24:27], a[88:91], v[16:31]
    ds_read_b128 a[52:55], v100 offset:416
    ds_read_b128 a[116:119], v101 offset:14672
    s_xor_b32 s13, s32, 8192
    s_xor_b32 s14, s32, 4096
    s_sub_u32 s34, s13, s14
    s_xor_b32 s13, s32, 12288
    s_xor_b32 s14, s32, 8192
    s_sub_u32 s35, s13, s14
    s_waitcnt lgkmcnt(12)
    v_mfma_f32_32x32x16_bf16 v[16:31], a[28:31], a[92:95], v[16:31]
    ds_read_b128 a[56:59], v100 offset:448
    ds_read_b128 a[120:123], v101 offset:14704
    v_mov_b32 v39, 1.0
    v_lshrrev_b32 v98, 1, v9
    s_waitcnt lgkmcnt(12)
    v_mfma_f32_32x32x16_bf16 v[16:31], a[32:35], a[96:99], v[16:31]
    ds_read_b128 a[60:63], v100 offset:480
    ds_read_b128 a[124:127], v101 offset:14736
    v_add_u32 v98, 135168, v98
    s_lshl_b32 s12, s3, 8
    s_waitcnt lgkmcnt(12)
    v_mfma_f32_32x32x16_bf16 v[16:31], a[36:39], a[100:103], v[16:31]
    s_mov_b32 m0, s12
    s_waitcnt lgkmcnt(10)
    v_mfma_f32_32x32x16_bf16 v[16:31], a[40:43], a[104:107], v[16:31]
    s_waitcnt lgkmcnt(8)
    v_mfma_f32_32x32x16_bf16 v[16:31], a[44:47], a[108:111], v[16:31]
    s_waitcnt lgkmcnt(6)
    v_mfma_f32_32x32x16_bf16 v[16:31], a[48:51], a[112:115], v[16:31]
    buffer_load_dwordx4 v[128:131], v9, s[48:51], s8 offen sc1
    buffer_load_dwordx4 v[112:115], v9, s[48:51], s16 offen sc1
    s_waitcnt lgkmcnt(4)
    v_mfma_f32_32x32x16_bf16 v[16:31], a[52:55], a[116:119], v[16:31]
    buffer_load_dwordx4 v[132:135], v9, s[48:51], s9 offen sc1
    buffer_load_dwordx4 v[116:119], v9, s[48:51], s17 offen sc1
    s_waitcnt lgkmcnt(2)
    v_mfma_f32_32x32x16_bf16 v[16:31], a[56:59], a[120:123], v[16:31]
    buffer_load_dwordx4 v[136:139], v9, s[48:51], s10 offen sc1
    buffer_load_dwordx4 v[120:123], v9, s[48:51], s18 offen sc1
    s_waitcnt lgkmcnt(0)
    v_mfma_f32_32x32x16_bf16 v[16:31], a[60:63], a[124:127], v[16:31]
    buffer_load_dwordx4 v[140:143], v9, s[48:51], s11 offen sc1
    buffer_load_dwordx4 v[124:127], v9, s[48:51], s19 offen sc1
    s_nop 9
    v_add_f32 v16, v16, v111
    v_cndmask_b32 v20, v20, v23, s[20:21]
    v_cvt_pk_bf16_f32 v20, v20, v21
    v_cvt_pk_bf16_f32 v21, v22, v23
    ds_write_b64 v102, v[20:21] offset:512
    v_cndmask_b32 v24, v24, v27, s[20:21]
    v_cvt_pk_bf16_f32 v24, v24, v25
    v_cvt_pk_bf16_f32 v25, v26, v27
    ds_write_b64 v102, v[24:25] offset:1024
    v_cndmask_b32 v28, v28, v31, s[20:21]
    v_cvt_pk_bf16_f32 v28, v28, v29
    v_cvt_pk_bf16_f32 v29, v30, v31
    ds_write_b64 v102, v[28:29] offset:1536
    v_cndmask_b32 v16, v16, v19, s[20:21]
    v_cvt_pk_bf16_f32 v16, v16, v17
    v_cvt_pk_bf16_f32 v17, v18, v19
    ds_write_b64 v102, v[16:17] offset:0
    s_waitcnt lgkmcnt(0)
    s_barrier
    ds_read_b128 v[64:67], v103 offset:0
    ds_read_b128 v[68:71], v103 offset:16
    ds_read_b128 v[40:43], v103 offset:34304
    ds_read_b128 v[44:47], v103 offset:34320
    v_and_b32 v24, 31, v1
    v_lshrrev_b32 v25, 5, v1
    v_mul_u32_u24 v25, 4608, v25
    v_lshl_add_u32 v24, v24, 4, v25
    v_mov_b32 v28, 0
    v_mov_b32 v29, 0
    v_mov_b32 v30, 0
    v_mov_b32 v31, 0
    ds_write_b128 v24, v[28:31] offset:4096
    s_waitcnt lgkmcnt(3)
    ds_write_b128 v103, v[66:69] offset:17216
    v_alignbit_b32 v72, v65, v64, 16
    v_alignbit_b32 v73, v66, v65, 16
    v_alignbit_b32 v74, v67, v66, 16
    v_alignbit_b32 v75, v68, v67, 16
    v_alignbit_b32 v76, v69, v68, 16
    v_alignbit_b32 v77, v70, v69, 16
    v_alignbit_b32 v78, v71, v70, 16
    ds_write_b128 v103, v[72:75] offset:4240
    v_pk_mov_b32 v[80:81], v[64:65], v[66:67] op_sel:[1,0]
    v_pk_mov_b32 v[82:83], v[66:67], v[68:69] op_sel:[1,0]
    v_pk_mov_b32 v[84:85], v[68:69], v[70:71] op_sel:[1,0]
    ds_write_b128 v103, v[74:77] offset:21456
    ds_write_b128 v103, v[80:83] offset:8608
    v_pk_mov_b32 v[88:89], v[72:73], v[74:75] op_sel:[1,0]
    v_pk_mov_b32 v[90:91], v[74:75], v[76:77] op_sel:[1,0]
    v_pk_mov_b32 v[92:93], v[76:77], v[78:79] op_sel:[1,0]
    ds_write_b128 v103, v[82:85] offset:25824
    ds_write_b128 v103, v[88:91] offset:12848
    ds_write_b128 v103, v[90:93] offset:30064
    s_waitcnt lgkmcnt(8)
    ds_write_b128 v103, v[42:45] offset:51520
    v_alignbit_b32 v48, v41, v40, 16
    v_alignbit_b32 v49, v42, v41, 16
    v_alignbit_b32 v50, v43, v42, 16
    v_alignbit_b32 v51, v44, v43, 16
    v_alignbit_b32 v52, v45, v44, 16
    v_alignbit_b32 v53, v46, v45, 16
    v_alignbit_b32 v54, v47, v46, 16
    ds_write_b128 v103, v[48:51] offset:38544
    v_pk_mov_b32 v[56:57], v[40:41], v[42:43] op_sel:[1,0]
    v_pk_mov_b32 v[58:59], v[42:43], v[44:45] op_sel:[1,0]
    v_pk_mov_b32 v[60:61], v[44:45], v[46:47] op_sel:[1,0]
    ds_write_b128 v103, v[50:53] offset:55760
    ds_write_b128 v103, v[56:59] offset:42912
    v_pk_mov_b32 v[80:81], v[48:49], v[50:51] op_sel:[1,0]
    v_pk_mov_b32 v[82:83], v[50:51], v[52:53] op_sel:[1,0]
    v_pk_mov_b32 v[84:85], v[52:53], v[54:55] op_sel:[1,0]
    ds_write_b128 v103, v[58:61] offset:60128
    ds_write_b128 v103, v[80:83] offset:47152
    ds_write_b128 v103, v[82:85] offset:64368
    s_waitcnt vmcnt(6)
    v_perm_b32 v26, v129, v128, s54
    v_perm_b32 v27, v131, v130, s55
    v_or_b32 v26, v26, v27
    v_bitop3_b32 v26, v26, v114, s43 bitop3:0x7e
    v_cmp_ne_u32 vcc, 0, v26
    s_cbranch_vccnz L_rg0
L_bg0:
    s_waitcnt lgkmcnt(14)
    ds_write_b64 v98, v[112:113] offset:0
    v_and_b32 v114, 0xffff0000, v112
    v_and_b32 v115, 0xffff0000, v113
    v_lshlrev_b32 v112, 16, v112
    v_lshlrev_b32 v113, 16, v113
    v_and_b32 v128, 0xffffff00, v128
    v_and_b32 v129, 0xffffff00, v129
    v_and_b32 v130, 0xffffff00, v130
    v_and_b32 v131, 0xffffff00, v131
    v_pk_fma_f32 v[112:113], v[112:113], v[128:129], v[130:131]
    v_pk_fma_f32 v[114:115], v[114:115], v[128:129], v[130:131]
    v_cvt_pk_bf16_f32 v112, v113, v112
    v_cvt_pk_bf16_f32 v114, v115, v114
    s_waitcnt lgkmcnt(14)
    ds_write_addtid_b32 v112 offset:3072
    s_waitcnt lgkmcnt(14)
    ds_write_addtid_b32 v114 offset:7680
    v_mov_b32 v64, -1
    v_mov_b32 v65, -1
    v_mov_b32 v66, -1
    v_mov_b32 v67, -1
    v_lshlrev_b32 v40, 4, v1
    v_mov_b32 v48, v226
    v_xor_b32 v41, 0, v144
    v_xor_b32 v42, 32, v144
    v_xor_b32 v43, 64, v144
    v_xor_b32 v44, 96, v144
    v_min_u32 v49, 1, v1
    v_lshlrev_b32 v49, 30, v49
    v_mov_b32 v50, s43
    s_waitcnt lgkmcnt(0)
    s_barrier
    ds_read_b128 a[144:147], v3 offset:3584
    ds_read_b128 a[148:151], v3 offset:3648
    ds_read_b128 a[152:155], v3 offset:3712
    ds_read_b128 a[156:159], v3 offset:3776
    ds_read_b128 a[160:163], v3 offset:3072
    ds_read_b128 a[164:167], v3 offset:3136
    ds_read_b128 a[168:171], v3 offset:3200
    ds_read_b128 a[172:175], v3 offset:3264
    ds_read_b128 a[80:83], v2 offset:0
    ds_read_b128 a[84:87], v2 offset:64
    global_load_dword v99, v10, s[28:29] sc1
    s_waitcnt lgkmcnt(1)
    v_mfma_f32_16x16x32_bf16 v[16:19], a[80:83], a[144:147], 0
    s_waitcnt vmcnt(5) lgkmcnt(0)
    ds_read_b128 a[88:91], v2 offset:128
    ds_read_b128 a[92:95], v2 offset:192
    ds_read_b128 a[96:99], v2 offset:512
    ds_read_b128 a[100:103], v2 offset:576
    ds_read_b128 a[104:107], v2 offset:640
    ds_read_b64_tr_b16 v[68:69], v41 offset:0
    ds_read_b64_tr_b16 v[70:71], v41 offset:2048
    v_perm_b32 v96, v133, v132, s54
    v_perm_b32 v97, v135, v134, s55
    v_or_b32 v96, v96, v97
    v_bitop3_b32 v96, v96, v118, s43 bitop3:0x7e
    v_mfma_f32_16x16x32_bf16 v[16:19], a[84:87], a[148:151], v[16:19]
    s_waitcnt lgkmcnt(6)
    ds_read_b128 v[108:111], v6 offset:0
    ds_read_b128 a[108:111], v2 offset:704
    ds_read_b64_tr_b16 v[72:73], v42 offset:0
    v_cmp_ne_u32 vcc, 0, v96
    v_mfma_f32_16x16x32_bf16 v[16:19], a[88:91], a[152:155], v[16:19]
    s_waitcnt lgkmcnt(8)
    ds_read_b128 a[112:115], v2 offset:1024
    ds_read_b128 a[116:119], v2 offset:1088
    s_cbranch_vccnz L_rg1
L_bg1:
    ds_write_b64 v98, v[116:117] offset:2048
    ds_read_b64_tr_b16 v[74:75], v42 offset:2048
    v_mfma_f32_16x16x32_bf16 v[16:19], a[92:95], a[156:159], v[16:19]
    ds_read_b128 a[120:123], v2 offset:1152
    ds_read_b128 a[124:127], v2 offset:1216
    ds_read_b64_tr_b16 v[76:77], v43 offset:0
    v_mfma_f32_16x16x32_bf16 v[20:23], a[80:83], a[160:163], 0
    s_waitcnt lgkmcnt(7)
    ds_read_b128 a[128:131], v2 offset:1536
    ds_read_b128 a[132:135], v2 offset:1600
    ds_read_b64_tr_b16 v[78:79], v43 offset:2048
    v_and_b32 v118, 0xffff0000, v116
    v_and_b32 v119, 0xffff0000, v117
    v_mfma_f32_16x16x32_bf16 v[20:23], a[84:87], a[164:167], v[20:23]
    ds_read_b128 a[136:139], v2 offset:1664
    v_perm_b32 v108, v108, v108, v8
    v_lshlrev_b32 v116, 16, v116
    v_lshlrev_b32 v117, 16, v117
    v_mfma_f32_16x16x32_bf16 v[20:23], a[88:91], a[168:171], v[20:23]
    v_perm_b32 v109, v109, v109, v8
    v_perm_b32 v110, v110, v110, v8
    v_and_b32 v132, 0xffffff00, v132
    v_and_b32 v133, 0xffffff00, v133
    v_mfma_f32_16x16x32_bf16 v[20:23], a[92:95], a[172:175], v[20:23]
    ds_read_b128 a[140:143], v2 offset:1728
    ds_read_b128 a[208:211], v2 offset:2048
    ds_read_b64_tr_b16 v[80:81], v44 offset:0
    v_and_b32 v134, 0xffffff00, v134
    v_and_b32 v135, 0xffffff00, v135
    v_mfma_f32_16x16x32_bf16 v[20:23], a[96:99], a[144:147], v[20:23]
    s_waitcnt lgkmcnt(4)
    ds_read_b128 a[212:215], v2 offset:2112
    ds_read_b128 a[216:219], v2 offset:2176
    v_fma_f32 v116, v116, v132, v134
    v_mfma_f32_16x16x32_bf16 v[20:23], a[100:103], a[148:151], v[20:23]
    ds_read_b128 a[220:223], v2 offset:2240
    ds_read_b128 a[224:227], v2 offset:2560
    ds_read_b64_tr_b16 v[82:83], v44 offset:2048
    s_xor_b32 s12, s73, 0
    buffer_store_dwordx4 v[68:71], v40, s[48:51], s12 offen sc1
    v_fma_f32 v117, v117, v133, v135
    v_fma_f32 v118, v118, v132, v134
    v_mfma_f32_16x16x32_bf16 v[20:23], a[104:107], a[152:155], v[20:23]
    ds_read_b128 a[228:231], v2 offset:2624
    ds_read_b128 a[232:235], v2 offset:2688
    v_fma_f32 v119, v119, v133, v135
    v_cvt_pk_bf16_f32 v116, v117, v116
    v_mfma_f32_16x16x32_bf16 v[20:23], a[108:111], a[156:159], v[20:23]
    ds_read_b128 a[236:239], v2 offset:2752
    v_perm_b32 v111, v111, v111, v8
    v_cvt_pk_bf16_f32 v118, v119, v118
    v_mfma_f32_16x16x32_bf16 v[24:27], a[96:99], a[160:163], 0
    ds_write_addtid_b32 v116 offset:2048
    ds_write_addtid_b32 v118 offset:6656
    s_xor_b32 s12, s73, 1024
    buffer_store_dwordx4 v[72:75], v40, s[48:51], s12 offen sc1
    v_mfma_f32_16x16x32_bf16 v[24:27], a[100:103], a[164:167], v[24:27]
    ds_write_b128 v4, v[16:19] offset:0
    v_mfma_f32_16x16x32_bf16 v[24:27], a[104:107], a[168:171], v[24:27]
    s_waitcnt vmcnt(2) lgkmcnt(6)
    ds_write_b128 v4, v[20:23] offset:2048
    v_cmp_ne_u32 vcc, s43, v99
    v_mfma_f32_16x16x32_bf16 v[24:27], a[108:111], a[172:175], v[24:27]
    s_cbranch_vccnz L_rw
L_bw:
    global_load_dword v52, v38, s[28:29] offset:0
    global_load_dword v53, v38, s[28:29] offset:256
    global_load_dword v54, v38, s[28:29] offset:512
    global_load_dword v55, v38, s[28:29] offset:768
    global_load_dword v56, v38, s[28:29] offset:1024
    global_load_dword v57, v38, s[28:29] offset:1280
    global_load_dword v58, v38, s[28:29] offset:1536
    global_load_dword v59, v38, s[28:29] offset:1792
    global_load_dword v60, v38, s[28:29] offset:2048
    global_load_dword v61, v38, s[28:29] offset:2304
    global_load_dword v62, v38, s[28:29] offset:2560
    global_load_dword v63, v38, s[28:29] offset:2816
    global_load_dwordx4 a[0:3], v32, s[28:29] offset:0
    v_mfma_f32_16x16x32_bf16 v[24:27], a[112:115], a[144:147], v[24:27]
    s_waitcnt lgkmcnt(0)
    s_barrier
    ds_read_b128 v[100:103], v5 offset:0
    ds_read_b128 v[104:107], v5 offset:4096
    global_load_dwordx4 a[4:7], v33, s[28:29] offset:0
    v_mfma_f32_16x16x32_bf16 v[24:27], a[116:119], a[148:151], v[24:27]
    ds_read_b128 a[176:179], v3 offset:2560
    ds_read_b128 a[180:183], v3 offset:2624
    v_mfma_f32_16x16x32_bf16 v[24:27], a[120:123], a[152:155], v[24:27]
    ds_read_b128 a[184:187], v3 offset:2688
    ds_read_b128 a[188:191], v3 offset:2752
    s_xor_b32 s12, s73, 2048
    buffer_store_dwordx4 v[76:79], v40, s[48:51], s12 offen sc1
    v_mfma_f32_16x16x32_bf16 v[24:27], a[124:127], a[156:159], v[24:27]
    ds_read_b128 a[192:195], v3 offset:2048
    ds_read_b128 a[196:199], v3 offset:2112
    v_perm_b32 v96, v137, v136, s54
    v_perm_b32 v97, v139, v138, s55
    v_mfma_f32_16x16x32_bf16 v[28:31], a[112:115], a[160:163], 0
    ds_read_b128 a[200:203], v3 offset:2176
    ds_read_b128 a[204:207], v3 offset:2240
    v_or_b32 v96, v96, v97
    v_mfma_f32_16x16x32_bf16 v[28:31], a[116:119], a[164:167], v[28:31]
    s_waitcnt lgkmcnt(9)
    v_bitop3_b32 v96, v96, v122, s43 bitop3:0x7e
    v_add_f32 v108, v108, v100
    v_mfma_f32_16x16x32_bf16 v[28:31], a[120:123], a[168:171], v[28:31]
    global_load_dwordx4 v[192:195], v34, s[28:29] offset:0
    v_add_f32 v109, v109, v101
    v_cmp_ne_u32 vcc, 0, v96
    v_mfma_f32_16x16x32_bf16 v[28:31], a[124:127], a[172:175], v[28:31]
    s_cbranch_vccnz L_rg2
L_bg2:
    v_add_f32 v110, v110, v102
    v_add_f32 v111, v111, v103
    v_mfma_f32_16x16x32_bf16 v[28:31], a[128:131], a[144:147], v[28:31]
    ds_write_b64 v98, v[120:121] offset:4096
    s_xor_b32 s12, s73, 3072
    buffer_store_dwordx4 v[80:83], v40, s[48:51], s12 offen sc1
    v_mfma_f32_16x16x32_bf16 v[28:31], a[132:135], a[148:151], v[28:31]
    s_waitcnt lgkmcnt(9)
    v_add_f32 v108, v108, v104
    v_add_f32 v109, v109, v105
    v_mfma_f32_16x16x32_bf16 v[28:31], a[136:139], a[152:155], v[28:31]
    v_add_f32 v110, v110, v106
    v_add_f32 v111, v111, v107
    v_and_b32 v122, 0xffff0000, v120
    v_mfma_f32_16x16x32_bf16 v[28:31], a[140:143], a[156:159], v[28:31]
    s_waitcnt lgkmcnt(8)
    global_load_dwordx4 a[8:11], v32, s[28:29] offset:1024
    v_cvt_pk_bf16_f32 v100, v108, v109
    v_cvt_pk_bf16_f32 v101, v110, v111
    v_and_b32 v123, 0xffff0000, v121
    v_mfma_f32_16x16x32_bf16 v[24:27], a[80:83], a[176:179], v[24:27]
    v_mov_b32 v102, v100 quad_perm:[1,1,3,3] row_mask:0xf bank_mask:0xf
    v_mov_b32 v103, v101 quad_perm:[1,1,3,3] row_mask:0xf bank_mask:0xf
    v_lshlrev_b32 v120, 16, v120
    v_mfma_f32_16x16x32_bf16 v[28:31], a[96:99], a[176:179], v[28:31]
    s_waitcnt lgkmcnt(7)
    buffer_store_dwordx4 v[100:103], v7, s[48:51], s52 offen sc1
    v_lshlrev_b32 v121, 16, v121
    v_mfma_f32_16x16x32_bf16 v[24:27], a[84:87], a[180:183], v[24:27]
    s_add_u32 s52, s52, 0x4000
    ds_read_b128 v[108:111], v6 offset:2048
    v_and_b32 v136, 0xffffff00, v136
    v_mfma_f32_16x16x32_bf16 v[28:31], a[100:103], a[180:183], v[28:31]
    s_waitcnt lgkmcnt(7)
    v_and_b32 v137, 0xffffff00, v137
    v_and_b32 v138, 0xffffff00, v138
    v_mfma_f32_16x16x32_bf16 v[24:27], a[88:91], a[184:187], v[24:27]
    v_and_b32 v139, 0xffffff00, v139
    v_fma_f32 v120, v120, v136, v138
    v_mfma_f32_16x16x32_bf16 v[28:31], a[104:107], a[184:187], v[28:31]
    s_waitcnt lgkmcnt(6)
    global_load_dwordx4 a[12:15], v33, s[28:29] offset:1024
    v_fma_f32 v121, v121, v137, v139
    v_mfma_f32_16x16x32_bf16 v[24:27], a[92:95], a[188:191], v[24:27]
    v_fma_f32 v122, v122, v136, v138
    v_fma_f32 v123, v123, v137, v139
    v_mfma_f32_16x16x32_bf16 v[28:31], a[108:111], a[188:191], v[28:31]
    s_waitcnt lgkmcnt(5)
    v_cvt_pk_bf16_f32 v120, v121, v120
    v_cvt_pk_bf16_f32 v122, v123, v122
    v_mfma_f32_16x16x32_bf16 v[28:31], a[80:83], a[192:195], v[28:31]
    s_waitcnt lgkmcnt(4)
    ds_write_addtid_b32 v120 offset:1024
    ds_write_addtid_b32 v122 offset:5632
    v_mfma_f32_16x16x32_bf16 v[28:31], a[84:87], a[196:199], v[28:31]
    s_waitcnt lgkmcnt(5)
    v_mfma_f32_16x16x32_bf16 v[28:31], a[88:91], a[200:203], v[28:31]
    s_waitcnt lgkmcnt(2)
    global_load_dwordx4 v[196:199], v34, s[28:29] offset:1024
    v_perm_b32 v108, v108, v108, v8
    v_mfma_f32_16x16x32_bf16 v[28:31], a[92:95], a[204:207], v[28:31]
    v_perm_b32 v109, v109, v109, v8
    v_perm_b32 v110, v110, v110, v8
    v_mfma_f32_16x16x32_bf16 v[16:19], a[96:99], a[192:195], 0
    v_perm_b32 v111, v111, v111, v8
    v_mfma_f32_16x16x32_bf16 v[16:19], a[100:103], a[196:199], v[16:19]
    ds_write_b128 v4, v[24:27] offset:8192
    global_load_dwordx4 a[16:19], v32, s[28:29] offset:2048
    v_mfma_f32_16x16x32_bf16 v[16:19], a[104:107], a[200:203], v[16:19]
    ds_write_b128 v4, v[28:31] offset:10240
    v_mfma_f32_16x16x32_bf16 v[16:19], a[108:111], a[204:207], v[16:19]
    v_mfma_f32_16x16x32_bf16 v[16:19], a[112:115], a[176:179], v[16:19]
    global_load_dwordx4 a[20:23], v33, s[28:29] offset:2048
    v_mfma_f32_16x16x32_bf16 v[16:19], a[116:119], a[180:183], v[16:19]
    v_mfma_f32_16x16x32_bf16 v[16:19], a[120:123], a[184:187], v[16:19]
    s_waitcnt lgkmcnt(0)
    s_barrier
    ds_read_b128 v[100:103], v5 offset:8192
    ds_read_b128 v[104:107], v5 offset:12288
    v_mfma_f32_16x16x32_bf16 v[16:19], a[124:127], a[188:191], v[16:19]
    ds_read_b128 a[240:243], v3 offset:1536
    ds_read_b128 a[244:247], v3 offset:1600
    global_load_dwordx4 v[200:203], v34, s[28:29] offset:2048
    v_perm_b32 v96, v141, v140, s54
    v_mfma_f32_16x16x32_bf16 v[16:19], a[128:131], a[160:163], v[16:19]
    ds_read_b128 a[248:251], v3 offset:1664
    ds_read_b128 a[252:255], v3 offset:1728
    v_perm_b32 v97, v143, v142, s55
    v_mfma_f32_16x16x32_bf16 v[16:19], a[132:135], a[164:167], v[16:19]
    v_or_b32 v96, v96, v97
    v_bitop3_b32 v96, v96, v126, s43 bitop3:0x7e
    v_mfma_f32_16x16x32_bf16 v[16:19], a[136:139], a[168:171], v[16:19]
    v_cmp_ne_u32 vcc, 0, v96
    v_mfma_f32_16x16x32_bf16 v[16:19], a[140:143], a[172:175], v[16:19]
    s_cbranch_vccnz L_rg3
L_bg3:
    global_load_dwordx4 a[24:27], v32, s[28:29] offset:3072
    v_mfma_f32_16x16x32_bf16 v[20:23], a[112:115], a[192:195], 0
    v_mfma_f32_16x16x32_bf16 v[20:23], a[116:119], a[196:199], v[20:23]
    s_waitcnt lgkmcnt(5)
    buffer_store_dwordx4 v[64:67], v40, s[48:51], s72 offen sc1
    s_add_u32 s72, s72, 4096
    s_cmp_lt_u32 s3, 2
    s_cselect_b32 s72, s72, 0x40000000
    buffer_store_dwordx4 v[64:67], v40, s[48:51], s72 offen sc1
    v_add_f32 v108, v108, v100
    v_add_f32 v109, v109, v101
    v_add_f32 v110, v110, v102
    v_add_f32 v111, v111, v103
    v_mfma_f32_16x16x32_bf16 v[20:23], a[120:123], a[200:203], v[20:23]
    s_waitcnt lgkmcnt(4)
    v_add_f32 v108, v108, v104
    v_add_f32 v109, v109, v105
    v_add_f32 v110, v110, v106
    v_add_f32 v111, v111, v107
    v_mfma_f32_16x16x32_bf16 v[20:23], a[124:127], a[204:207], v[20:23]
    v_cvt_pk_bf16_f32 v100, v108, v109
    v_cvt_pk_bf16_f32 v101, v110, v111
    v_mfma_f32_16x16x32_bf16 v[20:23], a[128:131], a[176:179], v[20:23]
    ds_write_b64 v98, v[124:125] offset:6144
    v_mov_b32 v102, v100 quad_perm:[1,1,3,3] row_mask:0xf bank_mask:0xf
    v_mov_b32 v103, v101 quad_perm:[1,1,3,3] row_mask:0xf bank_mask:0xf
    v_mfma_f32_16x16x32_bf16 v[20:23], a[132:135], a[180:183], v[20:23]
    buffer_store_dwordx4 v[100:103], v7, s[48:51], s52 offen sc1
    v_mfma_f32_16x16x32_bf16 v[20:23], a[136:139], a[184:187], v[20:23]
    s_add_u32 s52, s52, 0x4000
    v_and_b32 v126, 0xffff0000, v124
    v_and_b32 v127, 0xffff0000, v125
    v_mfma_f32_16x16x32_bf16 v[20:23], a[140:143], a[188:191], v[20:23]
    v_lshlrev_b32 v124, 16, v124
    v_lshlrev_b32 v125, 16, v125
    v_mfma_f32_16x16x32_bf16 v[16:19], a[208:211], a[144:147], v[16:19]
    v_and_b32 v140, 0xffffff00, v140
    v_and_b32 v141, 0xffffff00, v141
    v_mfma_f32_16x16x32_bf16 v[20:23], a[208:211], a[160:163], v[20:23]
    ds_read_b128 a[208:211], v3 offset:1024
    v_and_b32 v142, 0xffffff00, v142
    v_mfma_f32_16x16x32_bf16 v[16:19], a[212:215], a[148:151], v[16:19]
    global_load_dwordx4 a[28:31], v33, s[28:29] offset:3072
    v_and_b32 v143, 0xffffff00, v143
    v_mfma_f32_16x16x32_bf16 v[20:23], a[212:215], a[164:167], v[20:23]
    ds_read_b128 a[212:215], v3 offset:1088
    v_fma_f32 v124, v124, v140, v142
    v_mfma_f32_16x16x32_bf16 v[16:19], a[216:219], a[152:155], v[16:19]
    v_fma_f32 v125, v125, v141, v143
    v_fma_f32 v126, v126, v140, v142
    v_mfma_f32_16x16x32_bf16 v[20:23], a[216:219], a[168:171], v[20:23]
    ds_read_b128 a[216:219], v3 offset:1152
    v_fma_f32 v127, v127, v141, v143
    v_mfma_f32_16x16x32_bf16 v[16:19], a[220:223], a[156:159], v[16:19]
    global_load_dwordx4 v[204:207], v34, s[28:29] offset:3072
    v_cvt_pk_bf16_f32 v124, v125, v124
    v_mfma_f32_16x16x32_bf16 v[20:23], a[220:223], a[172:175], v[20:23]
    ds_read_b128 a[220:223], v3 offset:1216
    v_cvt_pk_bf16_f32 v126, v127, v126
    v_mfma_f32_16x16x32_bf16 v[20:23], a[224:227], a[144:147], v[20:23]
    ds_write_addtid_b32 v124 offset:0
    ds_write_addtid_b32 v126 offset:4608
    v_mfma_f32_16x16x32_bf16 v[20:23], a[228:231], a[148:151], v[20:23]
    v_mfma_f32_16x16x32_bf16 v[20:23], a[232:235], a[152:155], v[20:23]
    v_add_u32 v32, s33, v32
    global_load_dwordx4 a[32:35], v32, s[28:29] offset:0
    v_mfma_f32_16x16x32_bf16 v[20:23], a[236:239], a[156:159], v[20:23]
    s_waitcnt lgkmcnt(10)
    v_mfma_f32_16x16x32_bf16 v[16:19], a[80:83], a[240:243], v[16:19]
    v_mfma_f32_16x16x32_bf16 v[20:23], a[96:99], a[240:243], v[20:23]
    s_waitcnt lgkmcnt(9)
    ds_read_b128 v[108:111], v6 offset:4096
    v_mfma_f32_16x16x32_bf16 v[16:19], a[84:87], a[244:247], v[16:19]
    v_add_u32 v33, s33, v33
    global_load_dwordx4 a[36:39], v33, s[28:29] offset:0
    v_mfma_f32_16x16x32_bf16 v[20:23], a[100:103], a[244:247], v[20:23]
    s_waitcnt lgkmcnt(9)
    v_mfma_f32_16x16x32_bf16 v[16:19], a[88:91], a[248:251], v[16:19]
    v_mfma_f32_16x16x32_bf16 v[20:23], a[104:107], a[248:251], v[20:23]
    s_waitcnt lgkmcnt(8)
    v_mfma_f32_16x16x32_bf16 v[16:19], a[92:95], a[252:255], v[16:19]
    v_add_u32 v34, s33, v34
    global_load_dwordx4 v[208:211], v34, s[28:29] offset:0
    v_mfma_f32_16x16x32_bf16 v[20:23], a[108:111], a[252:255], v[20:23]
    s_waitcnt lgkmcnt(6)
    v_mfma_f32_16x16x32_bf16 v[20:23], a[80:83], a[208:211], v[20:23]
    s_waitcnt lgkmcnt(5)
    v_mfma_f32_16x16x32_bf16 v[20:23], a[84:87], a[212:215], v[20:23]
    s_waitcnt lgkmcnt(0)
    v_perm_b32 v108, v108, v108, v8
    v_perm_b32 v109, v109, v109, v8
    v_mfma_f32_16x16x32_bf16 v[20:23], a[88:91], a[216:219], v[20:23]
    global_load_dwordx4 a[40:43], v32, s[28:29] offset:1024
    v_perm_b32 v110, v110, v110, v8
    v_mfma_f32_16x16x32_bf16 v[20:23], a[92:95], a[220:223], v[20:23]
    v_perm_b32 v111, v111, v111, v8
    v_mfma_f32_16x16x32_bf16 v[24:27], a[112:115], a[240:243], 0
    v_mfma_f32_16x16x32_bf16 v[28:31], a[128:131], a[240:243], 0
    ds_write_b128 v4, v[16:19] offset:0
    global_load_dwordx4 a[44:47], v33, s[28:29] offset:1024
    v_mfma_f32_16x16x32_bf16 v[24:27], a[116:119], a[244:247], v[24:27]
    ds_read_b128 a[240:243], v2 offset:2048
    v_mfma_f32_16x16x32_bf16 v[28:31], a[132:135], a[244:247], v[28:31]
    ds_write_b128 v4, v[20:23] offset:2048
    v_mfma_f32_16x16x32_bf16 v[24:27], a[120:123], a[248:251], v[24:27]
    ds_read_b128 a[244:247], v2 offset:2112
    global_load_dwordx4 v[212:215], v34, s[28:29] offset:1024
    v_mfma_f32_16x16x32_bf16 v[28:31], a[136:139], a[248:251], v[28:31]
    ds_read_b128 a[248:251], v2 offset:2176
    v_mfma_f32_16x16x32_bf16 v[24:27], a[124:127], a[252:255], v[24:27]
    v_mfma_f32_16x16x32_bf16 v[28:31], a[140:143], a[252:255], v[28:31]
    s_waitcnt lgkmcnt(2)
    s_barrier
    ds_read_b128 v[100:103], v5 offset:0
    ds_read_b128 v[104:107], v5 offset:4096
    v_mfma_f32_16x16x32_bf16 v[24:27], a[96:99], a[208:211], v[24:27]
    ds_read_b128 a[252:255], v2 offset:2240
    global_load_dwordx4 a[48:51], v32, s[28:29] offset:2048
    v_mfma_f32_16x16x32_bf16 v[28:31], a[112:115], a[208:211], v[28:31]
    ds_read_b128 a[208:211], v2 offset:3072
    v_mfma_f32_16x16x32_bf16 v[24:27], a[100:103], a[212:215], v[24:27]
    v_mfma_f32_16x16x32_bf16 v[28:31], a[116:119], a[212:215], v[28:31]
    ds_read_b128 a[212:215], v2 offset:3136
    v_mfma_f32_16x16x32_bf16 v[24:27], a[104:107], a[216:219], v[24:27]
    global_load_dwordx4 a[52:55], v33, s[28:29] offset:2048
    v_mfma_f32_16x16x32_bf16 v[28:31], a[120:123], a[216:219], v[28:31]
    ds_read_b128 a[216:219], v2 offset:3200
    v_mfma_f32_16x16x32_bf16 v[24:27], a[108:111], a[220:223], v[24:27]
    v_mfma_f32_16x16x32_bf16 v[28:31], a[124:127], a[220:223], v[28:31]
    s_waitcnt lgkmcnt(4)
    ds_read_b128 a[220:223], v2 offset:3264
    v_add_f32 v108, v108, v100
    v_add_f32 v109, v109, v101
    v_add_f32 v110, v110, v102
    v_add_f32 v111, v111, v103
    v_add_f32 v108, v108, v104
    v_add_f32 v109, v109, v105
    v_add_f32 v110, v110, v106
    v_add_f32 v111, v111, v107
    v_cvt_pk_bf16_f32 v100, v108, v109
    v_cvt_pk_bf16_f32 v101, v110, v111
    v_mfma_f32_16x16x32_bf16 v[24:27], a[128:131], a[192:195], v[24:27]
    global_load_dwordx4 v[216:219], v34, s[28:29] offset:2048
    v_mov_b32 v102, v100 quad_perm:[1,1,3,3] row_mask:0xf bank_mask:0xf
    v_mov_b32 v103, v101 quad_perm:[1,1,3,3] row_mask:0xf bank_mask:0xf
    v_mfma_f32_16x16x32_bf16 v[24:27], a[132:135], a[196:199], v[24:27]
    v_mfma_f32_16x16x32_bf16 v[24:27], a[136:139], a[200:203], v[24:27]
    s_waitcnt vmcnt(12)
    global_load_dwordx4 a[56:59], v32, s[28:29] offset:3072
    buffer_store_dwordx4 v[100:103], v7, s[48:51], s52 offen sc1
    v_mfma_f32_16x16x32_bf16 v[24:27], a[140:143], a[204:207], v[24:27]
    s_add_u32 s52, s52, 0x4000
    v_mfma_f32_16x16x32_bf16 v[24:27], a[240:243], a[176:179], v[24:27]
    v_mfma_f32_16x16x32_bf16 v[28:31], a[240:243], a[192:195], v[28:31]
    ds_read_b128 a[240:243], v2 offset:3584
    v_mfma_f32_16x16x32_bf16 v[24:27], a[244:247], a[180:183], v[24:27]
    v_mfma_f32_16x16x32_bf16 v[28:31], a[244:247], a[196:199], v[28:31]
    ds_read_b128 a[244:247], v2 offset:3648
    v_mfma_f32_16x16x32_bf16 v[24:27], a[248:251], a[184:187], v[24:27]
    v_mfma_f32_16x16x32_bf16 v[28:31], a[248:251], a[200:203], v[28:31]
    s_waitcnt lgkmcnt(6)
    ds_read_b128 a[248:251], v2 offset:3712
    global_load_dwordx4 a[60:63], v33, s[28:29] offset:3072
    v_mfma_f32_16x16x32_bf16 v[24:27], a[252:255], a[188:191], v[24:27]
    v_mfma_f32_16x16x32_bf16 v[28:31], a[252:255], a[204:207], v[28:31]
    ds_read_b128 a[252:255], v2 offset:3776
    v_mfma_f32_16x16x32_bf16 v[24:27], a[224:227], a[160:163], v[24:27]
    v_mfma_f32_16x16x32_bf16 v[28:31], a[224:227], a[176:179], v[28:31]
    ds_read_b128 a[224:227], v3 offset:512
    global_load_dwordx4 v[220:223], v34, s[28:29] offset:3072
    v_mfma_f32_16x16x32_bf16 v[24:27], a[228:231], a[164:167], v[24:27]
    v_mfma_f32_16x16x32_bf16 v[28:31], a[228:231], a[180:183], v[28:31]
    ds_read_b128 a[228:231], v3 offset:576
    v_mfma_f32_16x16x32_bf16 v[24:27], a[232:235], a[168:171], v[24:27]
    v_mfma_f32_16x16x32_bf16 v[28:31], a[232:235], a[184:187], v[28:31]
    ds_read_b128 a[232:235], v3 offset:640
    v_add_u32 v32, s34, v32
    global_load_dwordx4 a[64:67], v32, s[28:29] offset:0
    v_mfma_f32_16x16x32_bf16 v[24:27], a[236:239], a[172:175], v[24:27]
    v_mfma_f32_16x16x32_bf16 v[28:31], a[236:239], a[188:191], v[28:31]
    s_waitcnt lgkmcnt(10)
    ds_read_b128 a[236:239], v3 offset:704
    v_mfma_f32_16x16x32_bf16 v[24:27], a[208:211], a[144:147], v[24:27]
    buffer_store_dword v50, v49, s[48:51], s26 offen sc1
    v_add_u32 v33, s34, v33
    global_load_dwordx4 a[68:71], v33, s[28:29] offset:0
    v_mfma_f32_16x16x32_bf16 v[28:31], a[208:211], a[160:163], v[28:31]
    s_waitcnt lgkmcnt(10)
    ds_read_b128 a[208:211], v3 offset:0
    v_mfma_f32_16x16x32_bf16 v[24:27], a[212:215], a[148:151], v[24:27]
    v_mfma_f32_16x16x32_bf16 v[28:31], a[212:215], a[164:167], v[28:31]
    s_waitcnt lgkmcnt(10)
    ds_read_b128 a[212:215], v3 offset:64
    v_mfma_f32_16x16x32_bf16 v[24:27], a[216:219], a[152:155], v[24:27]
    global_load_dwordx4 v[68:71], v11, s[28:29] offset:0 sc1
    v_mfma_f32_16x16x32_bf16 v[28:31], a[216:219], a[168:171], v[28:31]
    s_waitcnt lgkmcnt(10)
    ds_read_b128 a[216:219], v3 offset:128
    v_mfma_f32_16x16x32_bf16 v[24:27], a[220:223], a[156:159], v[24:27]
    v_mfma_f32_16x16x32_bf16 v[28:31], a[220:223], a[172:175], v[28:31]
    s_waitcnt lgkmcnt(10)
    ds_read_b128 a[220:223], v3 offset:192
    v_mfma_f32_16x16x32_bf16 v[28:31], a[240:243], a[144:147], v[28:31]
    s_waitcnt lgkmcnt(10)
    global_load_dwordx4 v[72:75], v11, s[28:29] offset:1024 sc1
    v_mfma_f32_16x16x32_bf16 v[28:31], a[244:247], a[148:151], v[28:31]
    s_waitcnt lgkmcnt(9)
    v_mfma_f32_16x16x32_bf16 v[28:31], a[248:251], a[152:155], v[28:31]
    s_waitcnt lgkmcnt(8)
    v_mfma_f32_16x16x32_bf16 v[28:31], a[252:255], a[156:159], v[28:31]
    s_waitcnt lgkmcnt(7)
    v_mfma_f32_16x16x32_bf16 v[24:27], a[80:83], a[224:227], v[24:27]
    global_load_dwordx4 v[76:79], v11, s[28:29] offset:2048 sc1
    v_mfma_f32_16x16x32_bf16 v[28:31], a[96:99], a[224:227], v[28:31]
    s_waitcnt lgkmcnt(6)
    ds_read_b128 v[108:111], v6 offset:6144
    v_mfma_f32_16x16x32_bf16 v[24:27], a[84:87], a[228:231], v[24:27]
    v_mfma_f32_16x16x32_bf16 v[28:31], a[100:103], a[228:231], v[28:31]
    s_waitcnt lgkmcnt(6)
    v_mfma_f32_16x16x32_bf16 v[24:27], a[88:91], a[232:235], v[24:27]
    global_load_dwordx4 v[80:83], v11, s[28:29] offset:3072 sc1
    v_add_u32 v11, 0x4000, v11
    v_mfma_f32_16x16x32_bf16 v[28:31], a[104:107], a[232:235], v[28:31]
    s_waitcnt lgkmcnt(5)
    v_mfma_f32_16x16x32_bf16 v[24:27], a[92:95], a[236:239], v[24:27]
    v_mfma_f32_16x16x32_bf16 v[28:31], a[108:111], a[236:239], v[28:31]
    s_waitcnt lgkmcnt(4)
    v_mfma_f32_16x16x32_bf16 v[28:31], a[80:83], a[208:211], v[28:31]
    s_waitcnt lgkmcnt(3)
    global_load_dwordx4 v[84:87], v11, s[28:29] offset:0 sc1
    v_mfma_f32_16x16x32_bf16 v[28:31], a[84:87], a[212:215], v[28:31]
    s_waitcnt lgkmcnt(0)
    v_perm_b32 v108, v108, v108, v8
    v_perm_b32 v109, v109, v109, v8
    v_mfma_f32_16x16x32_bf16 v[28:31], a[88:91], a[216:219], v[28:31]
    v_perm_b32 v110, v110, v110, v8
    v_perm_b32 v111, v111, v111, v8
    v_mfma_f32_16x16x32_bf16 v[28:31], a[92:95], a[220:223], v[28:31]
    ds_write_b128 v4, v[24:27] offset:8192
    v_add_u32 v34, s34, v34
    global_load_dwordx4 v[224:227], v34, s[28:29] offset:0
    global_load_dwordx4 v[88:91], v11, s[28:29] offset:1024 sc1
    global_load_dwordx4 v[92:95], v11, s[28:29] offset:2048 sc1
    global_load_dwordx4 v[96:99], v11, s[28:29] offset:3072 sc1
    s_nop 1
    ds_write_b128 v4, v[28:31] offset:10240
    s_waitcnt lgkmcnt(0)
    s_barrier
    ds_read_b128 v[100:103], v5 offset:8192
    ds_read_b128 v[104:107], v5 offset:12288
    s_waitcnt lgkmcnt(1)
    v_add_f32 v108, v108, v100
    v_add_f32 v109, v109, v101
    v_add_f32 v110, v110, v102
    v_add_f32 v111, v111, v103
    s_waitcnt lgkmcnt(0)
    v_add_f32 v108, v108, v104
    v_add_f32 v109, v109, v105
    v_add_f32 v110, v110, v106
    v_add_f32 v111, v111, v107
    v_cvt_pk_bf16_f32 v100, v108, v109
    v_cvt_pk_bf16_f32 v101, v110, v111
    s_nop 0
    v_mov_b32 v102, v100 quad_perm:[1,1,3,3] row_mask:0xf bank_mask:0xf
    v_mov_b32 v103, v101 quad_perm:[1,1,3,3] row_mask:0xf bank_mask:0xf
    buffer_store_dwordx4 v[100:103], v7, s[48:51], s52 offen sc1
    v_lshl_add_u32 v4, v1, 4, s62
    v_min_u32 v124, 10, v1
    v_lshl_add_u32 v124, v124, 8, s59
    s_or_b32 s12, s2, s3
    s_cmp_eq_u32 s12, 0
    s_cselect_b32 s12, 0, 0x40000000
    s_add_u32 s13, s44, 1
    v_mov_b32 v102, s13
    s_mov_b64 exec, 1
    buffer_store_dword v102, off, s[48:51], s12 sc1
    s_mov_b64 exec, -1
    v_add_f32 v52, v52, v53
    v_add_f32 v54, v54, v55
    v_add_f32 v52, v52, v54
    v_add_f32 v56, v56, v57
    v_add_f32 v58, v58, v59
    v_add_f32 v56, v56, v58
    v_add_f32 v60, v60, v61
    v_add_f32 v62, v62, v63
    v_add_f32 v60, v60, v62
    v_lshl_add_u32 v2, v1, 3, s60
    s_xor_b32 s12, s32, 0
    v_add_u32 v128, s12, v2
    s_xor_b32 s12, s32, 4096
    v_add_u32 v129, s12, v2
    s_xor_b32 s12, s32, 8192
    v_add_u32 v130, s12, v2
    s_xor_b32 s12, s32, 12288
    v_add_u32 v131, s12, v2
    v_lshl_add_u32 v3, v1, 4, s61
    v_mfma_f32_16x16x4_f32 v[40:43], v52, v39, 0
    v_mfma_f32_16x16x4_f32 v[44:47], v56, v39, 0
    v_mfma_f32_16x16x4_f32 v[48:51], v60, v39, 0
    v_lshl_add_u32 v5, v1, 4, s63
    v_lshl_add_u32 v6, v1, 4, s64
    v_lshl_add_u32 v7, v1, 4, s65
    v_lshl_add_u32 v8, v1, 4, s66
    v_lshl_add_u32 v9, v1, 4, s67
    v_lshl_add_u32 v10, v1, 3, s68
    s_waitcnt vmcnt(7)
    v_max3_u32 v100, v68, v69, v70
    v_max3_u32 v100, v100, v71, v72
    v_max3_u32 v100, v100, v73, v74
    v_max3_u32 v100, v100, v75, v76
    v_max3_u32 v100, v100, v77, v78
    global_load_dwordx4 a[72:75], v32, s[28:29] offset:1024
    v_max3_u32 v100, v100, v79, v80
    v_max3_u32 v100, v100, v81, v82
    v_max_u32 v100, v100, v83
    v_cmp_eq_u32 vcc, -1, v100
    s_cbranch_vccnz L_rh0
L_bh0:
    ds_write_b128 v12, v[68:71] offset:0
    ds_write_b128 v12, v[72:75] offset:1024
    ds_write_b128 v12, v[76:79] offset:2048
    global_load_dwordx4 a[76:79], v33, s[28:29] offset:1024
    ds_write_b128 v12, v[80:83] offset:3072
    s_waitcnt lgkmcnt(0)
    s_barrier
    s_cmp_eq_u32 s3, 3
    s_cbranch_scc1 L_g1b
    ds_read_b64_tr_b16 v[52:53], v128 offset:0
    ds_read_b64_tr_b16 v[54:55], v128 offset:512
    ds_read_b64_tr_b16 v[56:57], v128 offset:1024
    ds_read_b64_tr_b16 v[58:59], v128 offset:1536
    ds_read_b64_tr_b16 v[60:61], v128 offset:2048
    ds_read_b64_tr_b16 v[62:63], v128 offset:2560
    global_load_dwordx4 v[228:231], v34, s[28:29] offset:1024
    global_load_dwordx4 v[144:147], v32, s[28:29] offset:2048
    s_waitcnt lgkmcnt(4)
    v_mfma_f32_16x16x32_bf16 v[16:19], a[0:3], v[52:55], 0
    ds_read_b64_tr_b16 v[64:65], v128 offset:3072
    ds_read_b64_tr_b16 v[66:67], v128 offset:3584
    global_load_dwordx4 v[148:151], v33, s[28:29] offset:2048
    v_mfma_f32_16x16x32_bf16 v[20:23], a[4:7], v[52:55], 0
    v_mfma_f32_16x16x32_bf16 v[24:27], v[192:195], v[52:55], 0
    s_waitcnt lgkmcnt(4)
    ds_read_b64_tr_b16 v[52:53], v129 offset:0
    ds_read_b64_tr_b16 v[54:55], v129 offset:512
    global_load_dwordx4 v[232:235], v34, s[28:29] offset:2048
    v_mfma_f32_16x16x32_bf16 v[16:19], a[8:11], v[56:59], v[16:19]
    v_mfma_f32_16x16x32_bf16 v[20:23], a[12:15], v[56:59], v[20:23]
    v_mfma_f32_16x16x32_bf16 v[24:27], v[196:199], v[56:59], v[24:27]
    s_waitcnt lgkmcnt(4)
    ds_read_b64_tr_b16 v[56:57], v129 offset:1024
    ds_read_b64_tr_b16 v[58:59], v129 offset:1536
    v_mfma_f32_16x16x32_bf16 v[16:19], a[16:19], v[60:63], v[16:19]
    global_load_dwordx4 v[152:155], v32, s[28:29] offset:3072
    v_mfma_f32_16x16x32_bf16 v[20:23], a[20:23], v[60:63], v[20:23]
    v_mfma_f32_16x16x32_bf16 v[24:27], v[200:203], v[60:63], v[24:27]
    s_waitcnt lgkmcnt(4)
    ds_read_b64_tr_b16 v[60:61], v129 offset:2048
    ds_read_b64_tr_b16 v[62:63], v129 offset:2560
    v_add_u32 v11, 0x4000, v11
    v_mfma_f32_16x16x32_bf16 v[16:19], a[24:27], v[64:67], v[16:19]
    v_mfma_f32_16x16x32_bf16 v[20:23], a[28:31], v[64:67], v[20:23]
    global_load_dwordx4 v[156:159], v33, s[28:29] offset:3072
    v_mfma_f32_16x16x32_bf16 v[24:27], v[204:207], v[64:67], v[24:27]
    s_waitcnt lgkmcnt(4)
    ds_read_b64_tr_b16 v[64:65], v129 offset:3072
    ds_read_b64_tr_b16 v[66:67], v129 offset:3584
    v_mfma_f32_16x16x32_bf16 v[16:19], a[32:35], v[52:55], v[16:19]
    v_mfma_f32_16x16x32_bf16 v[20:23], a[36:39], v[52:55], v[20:23]
    v_mfma_f32_16x16x32_bf16 v[24:27], v[208:211], v[52:55], v[24:27]
    s_waitcnt lgkmcnt(4)
    ds_read_b64_tr_b16 v[52:53], v130 offset:0
    ds_read_b64_tr_b16 v[54:55], v130 offset:512
    global_load_dwordx4 v[236:239], v34, s[28:29] offset:3072
    v_mfma_f32_16x16x32_bf16 v[16:19], a[40:43], v[56:59], v[16:19]
    v_mfma_f32_16x16x32_bf16 v[20:23], a[44:47], v[56:59], v[20:23]
    v_mfma_f32_16x16x32_bf16 v[24:27], v[212:215], v[56:59], v[24:27]
    s_waitcnt lgkmcnt(4)
    ds_read_b64_tr_b16 v[56:57], v130 offset:1024
    ds_read_b64_tr_b16 v[58:59], v130 offset:1536
    v_mfma_f32_16x16x32_bf16 v[16:19], a[48:51], v[60:63], v[16:19]
    v_add_u32 v32, s35, v32
    global_load_dwordx4 v[160:163], v32, s[28:29] offset:0
    v_mfma_f32_16x16x32_bf16 v[20:23], a[52:55], v[60:63], v[20:23]
    v_mfma_f32_16x16x32_bf16 v[24:27], v[216:219], v[60:63], v[24:27]
    s_waitcnt lgkmcnt(4)
    ds_read_b64_tr_b16 v[60:61], v130 offset:2048
    ds_read_b64_tr_b16 v[62:63], v130 offset:2560
    v_mfma_f32_16x16x32_bf16 v[16:19], a[56:59], v[64:67], v[16:19]
    v_mfma_f32_16x16x32_bf16 v[20:23], a[60:63], v[64:67], v[20:23]
    v_add_u32 v33, s35, v33
    global_load_dwordx4 v[164:167], v33, s[28:29] offset:0
    v_mfma_f32_16x16x32_bf16 v[24:27], v[220:223], v[64:67], v[24:27]
    s_waitcnt lgkmcnt(4)
    ds_read_b64_tr_b16 v[64:65], v130 offset:3072
    ds_read_b64_tr_b16 v[66:67], v130 offset:3584
    v_mfma_f32_16x16x32_bf16 v[16:19], a[64:67], v[52:55], v[16:19]
    v_mfma_f32_16x16x32_bf16 v[20:23], a[68:71], v[52:55], v[20:23]
    s_waitcnt vmcnt(16)
    v_mfma_f32_16x16x32_bf16 v[24:27], v[224:227], v[52:55], v[24:27]
    s_waitcnt vmcnt(10) lgkmcnt(4)
    ds_read_b64_tr_b16 v[52:53], v131 offset:0
    ds_read_b64_tr_b16 v[54:55], v131 offset:512
    v_add_u32 v34, s35, v34
    global_load_dwordx4 v[240:243], v34, s[28:29] offset:0
    v_mfma_f32_16x16x32_bf16 v[16:19], a[72:75], v[56:59], v[16:19]
    s_waitcnt vmcnt(10)
    global_load_dwordx4 v[168:171], v32, s[28:29] offset:1024
    global_load_dwordx4 v[172:175], v33, s[28:29] offset:1024
    v_mfma_f32_16x16x32_bf16 v[20:23], a[76:79], v[56:59], v[20:23]
    s_waitcnt vmcnt(11)
    global_load_dwordx4 v[244:247], v34, s[28:29] offset:1024
    v_mfma_f32_16x16x32_bf16 v[24:27], v[228:231], v[56:59], v[24:27]
    s_waitcnt vmcnt(11) lgkmcnt(4)
    ds_read_b64_tr_b16 v[56:57], v131 offset:1024
    ds_read_b64_tr_b16 v[58:59], v131 offset:1536
    global_load_dwordx4 v[176:179], v32, s[28:29] offset:2048
    v_mfma_f32_16x16x32_bf16 v[16:19], v[144:147], v[60:63], v[16:19]
    s_waitcnt vmcnt(11)
    global_load_dwordx4 v[180:183], v33, s[28:29] offset:2048
    v_mfma_f32_16x16x32_bf16 v[20:23], v[148:151], v[60:63], v[20:23]
    s_waitcnt vmcnt(11)
    global_load_dwordx4 v[248:251], v34, s[28:29] offset:2048
    v_mfma_f32_16x16x32_bf16 v[24:27], v[232:235], v[60:63], v[24:27]
    s_waitcnt vmcnt(11) lgkmcnt(4)
    ds_read_b64_tr_b16 v[60:61], v131 offset:2048
    ds_read_b64_tr_b16 v[62:63], v131 offset:2560
    global_load_dwordx4 v[184:187], v32, s[28:29] offset:3072
    v_mfma_f32_16x16x32_bf16 v[16:19], v[152:155], v[64:67], v[16:19]
    s_waitcnt vmcnt(11)
    global_load_dwordx4 v[188:191], v33, s[28:29] offset:3072
    v_mfma_f32_16x16x32_bf16 v[20:23], v[156:159], v[64:67], v[20:23]
    s_waitcnt vmcnt(11)
    global_load_dwordx4 v[252:255], v34, s[28:29] offset:3072
    v_mfma_f32_16x16x32_bf16 v[24:27], v[236:239], v[64:67], v[24:27]
    s_waitcnt vmcnt(11) lgkmcnt(4)
    ds_read_b64_tr_b16 v[64:65], v131 offset:3072
    ds_read_b64_tr_b16 v[66:67], v131 offset:3584
    global_load_dwordx4 v[68:71], v11, s[28:29] offset:0 sc1
    v_mfma_f32_16x16x32_bf16 v[16:19], v[160:163], v[52:55], v[16:19]
    s_waitcnt vmcnt(11)
    global_load_dwordx4 v[72:75], v11, s[28:29] offset:1024 sc1
    v_mfma_f32_16x16x32_bf16 v[20:23], v[164:167], v[52:55], v[20:23]
    s_waitcnt vmcnt(11)
    global_load_dwordx4 v[76:79], v11, s[28:29] offset:2048 sc1
    v_mfma_f32_16x16x32_bf16 v[24:27], v[240:243], v[52:55], v[24:27]
    s_waitcnt vmcnt(11) lgkmcnt(4)
    global_load_dwordx4 v[80:83], v11, s[28:29] offset:3072 sc1
    v_max3_u32 v100, v84, v85, v86
    v_max3_u32 v100, v100, v87, v88
    v_max3_u32 v100, v100, v89, v90
    v_max3_u32 v100, v100, v91, v92
    v_max3_u32 v100, v100, v93, v94
    v_max3_u32 v100, v100, v95, v96
    v_max3_u32 v100, v100, v97, v98
    v_max_u32 v100, v100, v99
    v_cmp_eq_u32 vcc, -1, v100
    v_mfma_f32_16x16x32_bf16 v[16:19], v[168:171], v[56:59], v[16:19]
    s_waitcnt vmcnt(11)
    s_cbranch_vccnz L_rh1a
L_bh1a:
    ds_write_b128 v12, v[84:87] offset:16384
    ds_write_b128 v12, v[88:91] offset:17408
    ds_write_b128 v12, v[92:95] offset:18432
    ds_write_b128 v12, v[96:99] offset:19456
    global_load_dword v125, v124, s[28:29] sc1
    v_mfma_f32_16x16x32_bf16 v[20:23], v[172:175], v[56:59], v[20:23]
    s_waitcnt vmcnt(11)
    v_mfma_f32_16x16x32_bf16 v[24:27], v[244:247], v[56:59], v[24:27]
    s_waitcnt vmcnt(10) lgkmcnt(6)
    v_mfma_f32_16x16x32_bf16 v[16:19], v[176:179], v[60:63], v[16:19]
    s_waitcnt vmcnt(9) lgkmcnt(0)
    s_barrier
    ds_read_b64_tr_b16 v[52:53], v128 offset:16384
    ds_read_b64_tr_b16 v[54:55], v128 offset:16896
    ds_read_b64 v[112:113], v13 offset:0
    v_mfma_f32_16x16x32_bf16 v[20:23], v[180:183], v[60:63], v[20:23]
    s_waitcnt vmcnt(8)
    ds_read_b64_tr_b16 v[56:57], v128 offset:17408
    ds_read_b64_tr_b16 v[58:59], v128 offset:17920
    v_mfma_f32_16x16x32_bf16 v[24:27], v[248:251], v[60:63], v[24:27]
    s_waitcnt vmcnt(7)
    ds_read_b64_tr_b16 v[60:61], v128 offset:18432
    ds_read_b64_tr_b16 v[62:63], v128 offset:18944
    v_mfma_f32_16x16x32_bf16 v[16:19], v[184:187], v[64:67], v[16:19]
    s_waitcnt vmcnt(6)
    v_mfma_f32_16x16x32_bf16 v[20:23], v[188:191], v[64:67], v[20:23]
    s_waitcnt vmcnt(5)
    v_mfma_f32_16x16x32_bf16 v[24:27], v[252:255], v[64:67], v[24:27]
    s_waitcnt lgkmcnt(4)
    ds_read_b64_tr_b16 v[64:65], v128 offset:19456
    ds_read_b64_tr_b16 v[66:67], v128 offset:19968
    v_mul_f32 v116, v40, v113
    v_mul_f32 v117, v41, v113
    v_mul_f32 v118, v42, v113
    v_mfma_f32_16x16x32_bf16 v[28:31], a[0:3], v[52:55], 0
    v_mul_f32 v119, v43, v113
    v_fmac_f32 v116, v16, v112
    v_fmac_f32 v117, v17, v112
    v_mfma_f32_16x16x32_bf16 v[32:35], a[4:7], v[52:55], 0
    v_fmac_f32 v118, v18, v112
    v_fmac_f32 v119, v19, v112
    v_exp_f32 v120, v116
    v_mfma_f32_16x16x32_bf16 v[36:39], v[192:195], v[52:55], 0
    s_waitcnt lgkmcnt(4)
    ds_read_b64_tr_b16 v[52:53], v129 offset:16384
    ds_read_b64_tr_b16 v[54:55], v129 offset:16896
    v_exp_f32 v121, v117
    v_mfma_f32_16x16x32_bf16 v[28:31], a[8:11], v[56:59], v[28:31]
    v_exp_f32 v122, v118
    v_exp_f32 v123, v119
    v_mfma_f32_16x16x32_bf16 v[32:35], a[12:15], v[56:59], v[32:35]
    v_add_f32 v120, 1.0, v120
    v_add_f32 v121, 1.0, v121
    v_mfma_f32_16x16x32_bf16 v[36:39], v[196:199], v[56:59], v[36:39]
    s_waitcnt lgkmcnt(4)
    ds_read_b64_tr_b16 v[56:57], v129 offset:17408
    ds_read_b64_tr_b16 v[58:59], v129 offset:17920
    v_add_f32 v122, 1.0, v122
    v_add_f32 v123, 1.0, v123
    v_mfma_f32_16x16x32_bf16 v[28:31], a[16:19], v[60:63], v[28:31]
    v_rcp_f32 v120, v120
    v_rcp_f32 v121, v121
    v_mfma_f32_16x16x32_bf16 v[32:35], a[20:23], v[60:63], v[32:35]
    v_rcp_f32 v122, v122
    v_mfma_f32_16x16x32_bf16 v[36:39], v[200:203], v[60:63], v[36:39]
    s_waitcnt lgkmcnt(4)
    ds_read_b64_tr_b16 v[60:61], v129 offset:18432
    ds_read_b64_tr_b16 v[62:63], v129 offset:18944
    v_add_u32 v11, 0x4000, v11
    v_rcp_f32 v123, v123
    v_mul_f32 v120, v120, v116
    v_mfma_f32_16x16x32_bf16 v[28:31], a[24:27], v[64:67], v[28:31]
    global_load_dwordx4 v[84:87], v11, s[28:29] offset:0 sc1
    global_load_dwordx4 v[88:91], v11, s[28:29] offset:1024 sc1
    global_load_dwordx4 v[92:95], v11, s[28:29] offset:2048 sc1
    global_load_dwordx4 v[96:99], v11, s[28:29] offset:3072 sc1
    v_mul_f32 v121, v121, v117
    v_mul_f32 v122, v122, v118
    v_mfma_f32_16x16x32_bf16 v[32:35], a[28:31], v[64:67], v[32:35]
    s_waitcnt vmcnt(4)
    v_mul_f32 v123, v123, v119
    v_cvt_pk_bf16_f32 v132, v120, v121
    v_cvt_pk_bf16_f32 v133, v122, v123
    v_cmp_ne_u32 vcc, s43, v125
    v_mfma_f32_16x16x32_bf16 v[36:39], v[204:207], v[64:67], v[36:39]
    s_waitcnt lgkmcnt(4)
    ds_read_b64_tr_b16 v[64:65], v129 offset:19456
    ds_read_b64_tr_b16 v[66:67], v129 offset:19968
    s_cbranch_vccnz L_rw2a
L_bw2a:
    v_mul_f32 v116, v44, v113
    v_mul_f32 v117, v45, v113
    v_mul_f32 v118, v46, v113
    v_mfma_f32_16x16x32_bf16 v[28:31], a[32:35], v[52:55], v[28:31]
    global_load_dwordx4 a[80:83], v4, s[28:29] offset:-4096
    v_mul_f32 v119, v47, v113
    v_fmac_f32 v116, v20, v112
    v_fmac_f32 v117, v21, v112
    v_mfma_f32_16x16x32_bf16 v[32:35], a[36:39], v[52:55], v[32:35]
    v_fmac_f32 v118, v22, v112
    v_fmac_f32 v119, v23, v112
    v_exp_f32 v120, v116
    v_mfma_f32_16x16x32_bf16 v[36:39], v[208:211], v[52:55], v[36:39]
    s_waitcnt lgkmcnt(4)
    ds_read_b64_tr_b16 v[52:53], v130 offset:16384
    ds_read_b64_tr_b16 v[54:55], v130 offset:16896
    global_load_dwordx4 a[84:87], v4, s[28:29] offset:-3072
    v_exp_f32 v121, v117
    v_mfma_f32_16x16x32_bf16 v[28:31], a[40:43], v[56:59], v[28:31]
    v_max3_u32 v100, v68, v69, v70
    v_max3_u32 v100, v100, v71, v72
    v_max3_u32 v100, v100, v73, v74
    v_max3_u32 v100, v100, v75, v76
    v_max3_u32 v100, v100, v77, v78
    v_max3_u32 v100, v100, v79, v80
    v_max3_u32 v100, v100, v81, v82
    v_max_u32 v100, v100, v83
    v_cmp_eq_u32 vcc, -1, v100
    v_exp_f32 v122, v118
    v_mfma_f32_16x16x32_bf16 v[32:35], a[44:47], v[56:59], v[32:35]
    s_cbranch_vccnz L_rh2a
L_bh2a:
    ds_write_b128 v12, v[68:71] offset:32768
    ds_write_b128 v12, v[72:75] offset:33792
    ds_write_b128 v12, v[76:79] offset:34816
    ds_write_b128 v12, v[80:83] offset:35840
    global_load_dwordx4 a[88:91], v4, s[28:29] offset:-2048
    global_load_dwordx4 a[92:95], v4, s[28:29] offset:-1024
    v_exp_f32 v123, v119
    v_add_f32 v120, 1.0, v120
    v_mfma_f32_16x16x32_bf16 v[36:39], v[212:215], v[56:59], v[36:39]
    s_waitcnt lgkmcnt(8)
    ds_read_b64_tr_b16 v[56:57], v130 offset:17408
    ds_read_b64_tr_b16 v[58:59], v130 offset:17920
    global_load_dwordx4 a[96:99], v4, s[28:29] offset:0
    v_add_f32 v121, 1.0, v121
    v_add_f32 v122, 1.0, v122
    v_add_f32 v123, 1.0, v123
    v_mfma_f32_16x16x32_bf16 v[28:31], a[48:51], v[60:63], v[28:31]
    v_rcp_f32 v120, v120
    v_rcp_f32 v121, v121
    v_mfma_f32_16x16x32_bf16 v[32:35], a[52:55], v[60:63], v[32:35]
    v_rcp_f32 v122, v122
    v_mfma_f32_16x16x32_bf16 v[36:39], v[216:219], v[60:63], v[36:39]
    s_waitcnt lgkmcnt(8)
    ds_read_b64_tr_b16 v[60:61], v130 offset:18432
    ds_read_b64_tr_b16 v[62:63], v130 offset:18944
    global_load_dwordx4 a[100:103], v4, s[28:29] offset:1024
    v_rcp_f32 v123, v123
    v_mfma_f32_16x16x32_bf16 v[28:31], a[56:59], v[64:67], v[28:31]
    v_mul_f32 v120, v120, v116
    v_mul_f32 v121, v121, v117
    v_mul_f32 v122, v122, v118
    v_mfma_f32_16x16x32_bf16 v[32:35], a[60:63], v[64:67], v[32:35]
    v_mul_f32 v123, v123, v119
    v_cvt_pk_bf16_f32 v134, v120, v121
    v_cvt_pk_bf16_f32 v135, v122, v123
    v_mfma_f32_16x16x32_bf16 v[36:39], v[220:223], v[64:67], v[36:39]
    s_waitcnt lgkmcnt(8)
    ds_read_b64_tr_b16 v[64:65], v130 offset:19456
    ds_read_b64_tr_b16 v[66:67], v130 offset:19968
    buffer_store_dwordx4 v[132:135], v3, s[48:51], s53 offen sc1
    v_mfma_f32_16x16x32_bf16 v[28:31], a[64:67], v[52:55], v[28:31]
    v_mul_f32 v116, v48, v113
    v_mul_f32 v117, v49, v113
    v_mfma_f32_16x16x32_bf16 v[32:35], a[68:71], v[52:55], v[32:35]
    v_mul_f32 v118, v50, v113
    v_mul_f32 v119, v51, v113
    v_mfma_f32_16x16x32_bf16 v[36:39], v[224:227], v[52:55], v[36:39]
    s_waitcnt lgkmcnt(4)
    ds_read_b64_tr_b16 v[52:53], v131 offset:16384
    ds_read_b64_tr_b16 v[54:55], v131 offset:16896
    global_load_dwordx4 a[104:107], v4, s[28:29] offset:2048
    v_fmac_f32 v116, v24, v112
    v_fmac_f32 v117, v25, v112
    v_mfma_f32_16x16x32_bf16 v[28:31], a[72:75], v[56:59], v[28:31]
    v_fmac_f32 v118, v26, v112
    v_fmac_f32 v119, v27, v112
    v_exp_f32 v120, v116
    v_mfma_f32_16x16x32_bf16 v[32:35], a[76:79], v[56:59], v[32:35]
    v_exp_f32 v121, v117
    v_mfma_f32_16x16x32_bf16 v[36:39], v[228:231], v[56:59], v[36:39]
    s_waitcnt lgkmcnt(4)
    ds_read_b64_tr_b16 v[56:57], v131 offset:17408
    ds_read_b64_tr_b16 v[58:59], v131 offset:17920
    global_load_dwordx4 a[108:111], v4, s[28:29] offset:3072
    v_exp_f32 v122, v118
    v_add_u32 v4, 0x2000, v4
    v_mfma_f32_16x16x32_bf16 v[28:31], v[144:147], v[60:63], v[28:31]
    v_exp_f32 v123, v119
    v_add_f32 v120, 1.0, v120
    v_mfma_f32_16x16x32_bf16 v[32:35], v[148:151], v[60:63], v[32:35]
    v_add_f32 v121, 1.0, v121
    v_add_f32 v122, 1.0, v122
    v_add_f32 v123, 1.0, v123
    v_mfma_f32_16x16x32_bf16 v[36:39], v[232:235], v[60:63], v[36:39]
    s_waitcnt lgkmcnt(4)
    ds_read_b64_tr_b16 v[60:61], v131 offset:18432
    ds_read_b64_tr_b16 v[62:63], v131 offset:18944
    global_load_dwordx4 a[112:115], v4, s[28:29] offset:-4096
    v_rcp_f32 v120, v120
    v_rcp_f32 v121, v121
    v_mfma_f32_16x16x32_bf16 v[28:31], v[152:155], v[64:67], v[28:31]
    s_barrier
    ds_read_b64 v[114:115], v13 offset:128
    v_rcp_f32 v122, v122
    v_mfma_f32_16x16x32_bf16 v[32:35], v[156:159], v[64:67], v[32:35]
    global_load_dwordx4 a[116:119], v4, s[28:29] offset:-3072
    v_rcp_f32 v123, v123
    v_mfma_f32_16x16x32_bf16 v[36:39], v[236:239], v[64:67], v[36:39]
    s_waitcnt lgkmcnt(5)
    ds_read_b64_tr_b16 v[64:65], v131 offset:19456
    ds_read_b64_tr_b16 v[66:67], v131 offset:19968
    v_mul_f32 v120, v120, v116
    v_mul_f32 v121, v121, v117
    v_mul_f32 v122, v122, v118
    v_mfma_f32_16x16x32_bf16 v[28:31], v[160:163], v[52:55], v[28:31]
    v_mul_f32 v123, v123, v119
    v_cvt_pk_bf16_f32 v136, v120, v121
    v_cvt_pk_bf16_f32 v137, v122, v123
    v_mfma_f32_16x16x32_bf16 v[32:35], v[164:167], v[52:55], v[32:35]
    global_load_dwordx4 a[120:123], v4, s[28:29] offset:-2048
    v_permlane16_swap_b32 v136, v138
    v_permlane16_swap_b32 v137, v139
    v_mfma_f32_16x16x32_bf16 v[36:39], v[240:243], v[52:55], v[36:39]
    s_waitcnt lgkmcnt(5)
    ds_read_b64_tr_b16 v[52:53], v128 offset:32768
    ds_read_b64_tr_b16 v[54:55], v128 offset:33280
    buffer_store_dwordx4 v[136:139], v14, s[48:51], s53 offen sc1
    v_mfma_f32_16x16x32_bf16 v[28:31], v[168:171], v[56:59], v[28:31]
    s_add_u32 s53, s53, 180224
    v_mfma_f32_16x16x32_bf16 v[32:35], v[172:175], v[56:59], v[32:35]
    v_mfma_f32_16x16x32_bf16 v[36:39], v[244:247], v[56:59], v[36:39]
    s_waitcnt lgkmcnt(5)
    ds_read_b64_tr_b16 v[56:57], v128 offset:33792
    ds_read_b64_tr_b16 v[58:59], v128 offset:34304
    v_mfma_f32_16x16x32_bf16 v[28:31], v[176:179], v[60:63], v[28:31]
    v_mfma_f32_16x16x32_bf16 v[32:35], v[180:183], v[60:63], v[32:35]
    global_load_dwordx4 a[124:127], v4, s[28:29] offset:-1024
    v_mfma_f32_16x16x32_bf16 v[36:39], v[248:251], v[60:63], v[36:39]
    s_waitcnt lgkmcnt(4)
    ds_read_b64_tr_b16 v[60:61], v128 offset:34816
    ds_read_b64_tr_b16 v[62:63], v128 offset:35328
    v_mfma_f32_16x16x32_bf16 v[28:31], v[184:187], v[64:67], v[28:31]
    v_mfma_f32_16x16x32_bf16 v[32:35], v[188:191], v[64:67], v[32:35]
    v_mfma_f32_16x16x32_bf16 v[36:39], v[252:255], v[64:67], v[36:39]
    s_waitcnt lgkmcnt(4)
    ds_read_b64_tr_b16 v[64:65], v128 offset:35840
    ds_read_b64_tr_b16 v[66:67], v128 offset:36352
    global_load_dwordx4 a[128:131], v4, s[28:29] offset:0
    v_mul_f32 v116, v40, v115
    v_mul_f32 v117, v41, v115
    v_mul_f32 v118, v42, v115
    v_mfma_f32_16x16x32_bf16 v[16:19], a[0:3], v[52:55], 0
    v_mul_f32 v119, v43, v115
    v_fmac_f32 v116, v28, v114
    v_fmac_f32 v117, v29, v114
    v_mfma_f32_16x16x32_bf16 v[20:23], a[4:7], v[52:55], 0
    v_fmac_f32 v118, v30, v114
    v_fmac_f32 v119, v31, v114
    v_exp_f32 v120, v116
    v_mfma_f32_16x16x32_bf16 v[24:27], v[192:195], v[52:55], 0
    s_waitcnt lgkmcnt(4)
    ds_read_b64_tr_b16 v[52:53], v129 offset:32768
    ds_read_b64_tr_b16 v[54:55], v129 offset:33280
    global_load_dwordx4 a[132:135], v4, s[28:29] offset:1024
    v_exp_f32 v121, v117
    v_mfma_f32_16x16x32_bf16 v[16:19], a[8:11], v[56:59], v[16:19]
    v_exp_f32 v122, v118
    v_exp_f32 v123, v119
    v_mfma_f32_16x16x32_bf16 v[20:23], a[12:15], v[56:59], v[20:23]
    v_add_f32 v120, 1.0, v120
    v_add_f32 v121, 1.0, v121
    v_mfma_f32_16x16x32_bf16 v[24:27], v[196:199], v[56:59], v[24:27]
    s_waitcnt lgkmcnt(4)
    ds_read_b64_tr_b16 v[56:57], v129 offset:33792
    ds_read_b64_tr_b16 v[58:59], v129 offset:34304
    global_load_dwordx4 a[136:139], v4, s[28:29] offset:2048
    v_add_f32 v122, 1.0, v122
    v_add_f32 v123, 1.0, v123
    v_mfma_f32_16x16x32_bf16 v[16:19], a[16:19], v[60:63], v[16:19]
    v_rcp_f32 v120, v120
    v_rcp_f32 v121, v121
    v_mfma_f32_16x16x32_bf16 v[20:23], a[20:23], v[60:63], v[20:23]
    v_rcp_f32 v122, v122
    v_mfma_f32_16x16x32_bf16 v[24:27], v[200:203], v[60:63], v[24:27]
    s_waitcnt lgkmcnt(4)
    ds_read_b64_tr_b16 v[60:61], v129 offset:34816
    ds_read_b64_tr_b16 v[62:63], v129 offset:35328
    global_load_dwordx4 a[140:143], v4, s[28:29] offset:3072
    v_rcp_f32 v123, v123
    v_mul_f32 v120, v120, v116
    v_add_u32 v4, 0x2000, v4
    v_mfma_f32_16x16x32_bf16 v[16:19], a[24:27], v[64:67], v[16:19]
    v_mul_f32 v121, v121, v117
    v_mul_f32 v122, v122, v118
    v_mfma_f32_16x16x32_bf16 v[20:23], a[28:31], v[64:67], v[20:23]
    v_mul_f32 v123, v123, v119
    v_cvt_pk_bf16_f32 v132, v120, v121
    v_cvt_pk_bf16_f32 v133, v122, v123
    v_mfma_f32_16x16x32_bf16 v[24:27], v[204:207], v[64:67], v[24:27]
    s_waitcnt lgkmcnt(4)
    ds_read_b64_tr_b16 v[64:65], v129 offset:35840
    ds_read_b64_tr_b16 v[66:67], v129 offset:36352
    global_load_dwordx4 a[144:147], v4, s[28:29] offset:-4096
    v_mul_f32 v116, v44, v115
    v_mul_f32 v117, v45, v115
    v_mul_f32 v118, v46, v115
    v_mfma_f32_16x16x32_bf16 v[16:19], a[32:35], v[52:55], v[16:19]
    v_mul_f32 v119, v47, v115
    v_fmac_f32 v116, v32, v114
    v_fmac_f32 v117, v33, v114
    v_mfma_f32_16x16x32_bf16 v[20:23], a[36:39], v[52:55], v[20:23]
    global_load_dwordx4 a[148:151], v4, s[28:29] offset:-3072
    v_fmac_f32 v118, v34, v114
    v_fmac_f32 v119, v35, v114
    v_exp_f32 v120, v116
    v_mfma_f32_16x16x32_bf16 v[24:27], v[208:211], v[52:55], v[24:27]
    s_waitcnt lgkmcnt(4)
    ds_read_b64_tr_b16 v[52:53], v130 offset:32768
    ds_read_b64_tr_b16 v[54:55], v130 offset:33280
    v_exp_f32 v121, v117
    v_mfma_f32_16x16x32_bf16 v[16:19], a[40:43], v[56:59], v[16:19]
    s_waitcnt vmcnt(20)
    v_max3_u32 v100, v84, v85, v86
    v_max3_u32 v100, v100, v87, v88
    v_max3_u32 v100, v100, v89, v90
    v_max3_u32 v100, v100, v91, v92
    v_max3_u32 v100, v100, v93, v94
    v_max3_u32 v100, v100, v95, v96
    v_max3_u32 v100, v100, v97, v98
    v_max_u32 v100, v100, v99
    v_cmp_eq_u32 vcc, -1, v100
    v_exp_f32 v122, v118
    v_mfma_f32_16x16x32_bf16 v[20:23], a[44:47], v[56:59], v[20:23]
    s_cbranch_vccnz L_rh3a
L_bh3a:
    ds_write_b128 v12, v[84:87] offset:49152
    ds_write_b128 v12, v[88:91] offset:50176
    ds_write_b128 v12, v[92:95] offset:51200
    ds_write_b128 v12, v[96:99] offset:52224
    global_load_dwordx4 a[152:155], v4, s[28:29] offset:-2048
    global_load_dwordx4 a[156:159], v4, s[28:29] offset:-1024
    v_exp_f32 v123, v119
    v_add_f32 v120, 1.0, v120
    v_mfma_f32_16x16x32_bf16 v[24:27], v[212:215], v[56:59], v[24:27]
    s_waitcnt lgkmcnt(8)
    ds_read_b64_tr_b16 v[56:57], v130 offset:33792
    ds_read_b64_tr_b16 v[58:59], v130 offset:34304
    global_load_dwordx4 a[160:163], v4, s[28:29] offset:0
    v_add_f32 v121, 1.0, v121
    v_add_f32 v122, 1.0, v122
    v_add_f32 v123, 1.0, v123
    v_mfma_f32_16x16x32_bf16 v[16:19], a[48:51], v[60:63], v[16:19]
    v_rcp_f32 v120, v120
    v_rcp_f32 v121, v121
    v_mfma_f32_16x16x32_bf16 v[20:23], a[52:55], v[60:63], v[20:23]
    global_load_dwordx4 a[164:167], v4, s[28:29] offset:1024
    v_rcp_f32 v122, v122
    v_mfma_f32_16x16x32_bf16 v[24:27], v[216:219], v[60:63], v[24:27]
    s_waitcnt lgkmcnt(8)
    ds_read_b64_tr_b16 v[60:61], v130 offset:34816
    ds_read_b64_tr_b16 v[62:63], v130 offset:35328
    v_rcp_f32 v123, v123
    v_mfma_f32_16x16x32_bf16 v[16:19], a[56:59], v[64:67], v[16:19]
    v_mul_f32 v120, v120, v116
    v_mul_f32 v121, v121, v117
    v_mul_f32 v122, v122, v118
    v_mfma_f32_16x16x32_bf16 v[20:23], a[60:63], v[64:67], v[20:23]
    global_load_dwordx4 a[168:171], v4, s[28:29] offset:2048
    v_mul_f32 v123, v123, v119
    v_cvt_pk_bf16_f32 v134, v120, v121
    v_cvt_pk_bf16_f32 v135, v122, v123
    v_mfma_f32_16x16x32_bf16 v[24:27], v[220:223], v[64:67], v[24:27]
    s_waitcnt lgkmcnt(8)
    ds_read_b64_tr_b16 v[64:65], v130 offset:35840
    ds_read_b64_tr_b16 v[66:67], v130 offset:36352
    buffer_store_dwordx4 v[132:135], v3, s[48:51], s53 offen sc1
    v_mfma_f32_16x16x32_bf16 v[16:19], a[64:67], v[52:55], v[16:19]
    v_mul_f32 v116, v48, v115
    v_mul_f32 v117, v49, v115
    v_mfma_f32_16x16x32_bf16 v[20:23], a[68:71], v[52:55], v[20:23]
    v_mul_f32 v118, v50, v115
    v_mul_f32 v119, v51, v115
    v_mfma_f32_16x16x32_bf16 v[24:27], v[224:227], v[52:55], v[24:27]
    s_waitcnt lgkmcnt(4)
    ds_read_b64_tr_b16 v[52:53], v131 offset:32768
    ds_read_b64_tr_b16 v[54:55], v131 offset:33280
    v_fmac_f32 v116, v36, v114
    v_fmac_f32 v117, v37, v114
    v_mfma_f32_16x16x32_bf16 v[16:19], a[72:75], v[56:59], v[16:19]
    v_fmac_f32 v118, v38, v114
    v_fmac_f32 v119, v39, v114
    v_exp_f32 v120, v116
    v_mfma_f32_16x16x32_bf16 v[20:23], a[76:79], v[56:59], v[20:23]
    global_load_dwordx4 a[172:175], v4, s[28:29] offset:3072
    v_exp_f32 v121, v117
    v_add_u32 v4, 0x2000, v4
    v_mfma_f32_16x16x32_bf16 v[24:27], v[228:231], v[56:59], v[24:27]
    s_waitcnt lgkmcnt(4)
    ds_read_b64_tr_b16 v[56:57], v131 offset:33792
    ds_read_b64_tr_b16 v[58:59], v131 offset:34304
    v_exp_f32 v122, v118
    v_mfma_f32_16x16x32_bf16 v[16:19], v[144:147], v[60:63], v[16:19]
    global_load_dwordx4 a[176:179], v4, s[28:29] offset:-4096
    v_exp_f32 v123, v119
    v_add_f32 v120, 1.0, v120
    v_mfma_f32_16x16x32_bf16 v[20:23], v[148:151], v[60:63], v[20:23]
    v_add_f32 v121, 1.0, v121
    v_add_f32 v122, 1.0, v122
    v_add_f32 v123, 1.0, v123
    v_mfma_f32_16x16x32_bf16 v[24:27], v[232:235], v[60:63], v[24:27]
    s_waitcnt lgkmcnt(4)
    ds_read_b64_tr_b16 v[60:61], v131 offset:34816
    ds_read_b64_tr_b16 v[62:63], v131 offset:35328
    v_rcp_f32 v120, v120
    v_rcp_f32 v121, v121
    v_mfma_f32_16x16x32_bf16 v[16:19], v[152:155], v[64:67], v[16:19]
    s_barrier
    ds_read_b64 v[112:113], v13 offset:256
    global_load_dwordx4 a[180:183], v4, s[28:29] offset:-3072
    v_rcp_f32 v122, v122
    v_mfma_f32_16x16x32_bf16 v[20:23], v[156:159], v[64:67], v[20:23]
    v_rcp_f32 v123, v123
    v_mfma_f32_16x16x32_bf16 v[24:27], v[236:239], v[64:67], v[24:27]
    s_waitcnt lgkmcnt(5)
    ds_read_b64_tr_b16 v[64:65], v131 offset:35840
    ds_read_b64_tr_b16 v[66:67], v131 offset:36352
    v_mul_f32 v120, v120, v116
    v_mul_f32 v121, v121, v117
    v_mul_f32 v122, v122, v118
    v_mfma_f32_16x16x32_bf16 v[16:19], v[160:163], v[52:55], v[16:19]
    global_load_dwordx4 a[184:187], v4, s[28:29] offset:-2048
    v_mul_f32 v123, v123, v119
    v_cvt_pk_bf16_f32 v136, v120, v121
    v_cvt_pk_bf16_f32 v137, v122, v123
    v_mfma_f32_16x16x32_bf16 v[20:23], v[164:167], v[52:55], v[20:23]
    v_permlane16_swap_b32 v136, v138
    v_permlane16_swap_b32 v137, v139
    v_mfma_f32_16x16x32_bf16 v[24:27], v[240:243], v[52:55], v[24:27]
    s_waitcnt lgkmcnt(5)
    ds_read_b64_tr_b16 v[52:53], v128 offset:49152
    ds_read_b64_tr_b16 v[54:55], v128 offset:49664
    buffer_store_dwordx4 v[136:139], v14, s[48:51], s53 offen sc1
    v_mfma_f32_16x16x32_bf16 v[16:19], v[168:171], v[56:59], v[16:19]
    s_add_u32 s53, s53, 180224
    v_mfma_f32_16x16x32_bf16 v[20:23], v[172:175], v[56:59], v[20:23]
    v_mfma_f32_16x16x32_bf16 v[24:27], v[244:247], v[56:59], v[24:27]
    s_waitcnt lgkmcnt(5)
    ds_read_b64_tr_b16 v[56:57], v128 offset:50176
    ds_read_b64_tr_b16 v[58:59], v128 offset:50688
    global_load_dwordx4 a[188:191], v4, s[28:29] offset:-1024
    v_mfma_f32_16x16x32_bf16 v[16:19], v[176:179], v[60:63], v[16:19]
    v_mfma_f32_16x16x32_bf16 v[20:23], v[180:183], v[60:63], v[20:23]
    v_mfma_f32_16x16x32_bf16 v[24:27], v[248:251], v[60:63], v[24:27]
    s_waitcnt lgkmcnt(4)
    ds_read_b64_tr_b16 v[60:61], v128 offset:51200
    ds_read_b64_tr_b16 v[62:63], v128 offset:51712
    v_mfma_f32_16x16x32_bf16 v[16:19], v[184:187], v[64:67], v[16:19]
    v_mfma_f32_16x16x32_bf16 v[20:23], v[188:191], v[64:67], v[20:23]
    global_load_dwordx4 a[192:195], v4, s[28:29] offset:0
    v_mfma_f32_16x16x32_bf16 v[24:27], v[252:255], v[64:67], v[24:27]
    s_waitcnt lgkmcnt(4)
    ds_read_b64_tr_b16 v[64:65], v128 offset:52224
    ds_read_b64_tr_b16 v[66:67], v128 offset:52736
    v_mul_f32 v116, v40, v113
    v_mul_f32 v117, v41, v113
    v_mul_f32 v118, v42, v113
    v_mfma_f32_16x16x32_bf16 v[28:31], a[0:3], v[52:55], 0
    v_mul_f32 v119, v43, v113
    v_fmac_f32 v116, v16, v112
    v_fmac_f32 v117, v17, v112
    v_mfma_f32_16x16x32_bf16 v[32:35], a[4:7], v[52:55], 0
    global_load_dwordx4 a[196:199], v4, s[28:29] offset:1024
    v_fmac_f32 v118, v18, v112
    v_fmac_f32 v119, v19, v112
    v_exp_f32 v120, v116
    v_mfma_f32_16x16x32_bf16 v[36:39], v[192:195], v[52:55], 0
    s_waitcnt lgkmcnt(4)
    ds_read_b64_tr_b16 v[52:53], v129 offset:49152
    ds_read_b64_tr_b16 v[54:55], v129 offset:49664
    v_exp_f32 v121, v117
    v_mfma_f32_16x16x32_bf16 v[28:31], a[8:11], v[56:59], v[28:31]
    v_exp_f32 v122, v118
    v_exp_f32 v123, v119
    v_mfma_f32_16x16x32_bf16 v[32:35], a[12:15], v[56:59], v[32:35]
    global_load_dwordx4 a[200:203], v4, s[28:29] offset:2048
    v_add_f32 v120, 1.0, v120
    v_mfma_f32_16x16x32_bf16 v[36:39], v[196:199], v[56:59], v[36:39]
    s_waitcnt lgkmcnt(4)
    ds_read_b64_tr_b16 v[56:57], v129 offset:50176
    ds_read_b64_tr_b16 v[58:59], v129 offset:50688
    v_add_f32 v121, 1.0, v121
    v_add_f32 v122, 1.0, v122
    v_add_f32 v123, 1.0, v123
    v_mfma_f32_16x16x32_bf16 v[28:31], a[16:19], v[60:63], v[28:31]
    v_rcp_f32 v120, v120
    v_rcp_f32 v121, v121
    v_mfma_f32_16x16x32_bf16 v[32:35], a[20:23], v[60:63], v[32:35]
    global_load_dwordx4 a[204:207], v4, s[28:29] offset:3072
    v_rcp_f32 v122, v122
    v_add_u32 v4, 0x2000, v4
    v_mfma_f32_16x16x32_bf16 v[36:39], v[200:203], v[60:63], v[36:39]
    s_waitcnt lgkmcnt(4)
    ds_read_b64_tr_b16 v[60:61], v129 offset:51200
    ds_read_b64_tr_b16 v[62:63], v129 offset:51712
    v_rcp_f32 v123, v123
    v_mul_f32 v120, v120, v116
    v_mfma_f32_16x16x32_bf16 v[28:31], a[24:27], v[64:67], v[28:31]
    global_load_dwordx4 a[208:211], v4, s[28:29] offset:-4096
    v_mul_f32 v121, v121, v117
    v_mul_f32 v122, v122, v118
    v_mfma_f32_16x16x32_bf16 v[32:35], a[28:31], v[64:67], v[32:35]
    v_mul_f32 v123, v123, v119
    v_cvt_pk_bf16_f32 v132, v120, v121
    v_cvt_pk_bf16_f32 v133, v122, v123
    v_mfma_f32_16x16x32_bf16 v[36:39], v[204:207], v[64:67], v[36:39]
    s_waitcnt lgkmcnt(4)
    ds_read_b64_tr_b16 v[64:65], v129 offset:52224
    ds_read_b64_tr_b16 v[66:67], v129 offset:52736
    v_mul_f32 v116, v44, v113
    v_mul_f32 v117, v45, v113
    v_mul_f32 v118, v46, v113
    v_mfma_f32_16x16x32_bf16 v[28:31], a[32:35], v[52:55], v[28:31]
    global_load_dwordx4 a[212:215], v4, s[28:29] offset:-3072
    v_mul_f32 v119, v47, v113
    v_fmac_f32 v116, v20, v112
    v_fmac_f32 v117, v21, v112
    v_mfma_f32_16x16x32_bf16 v[32:35], a[36:39], v[52:55], v[32:35]
    v_fmac_f32 v118, v22, v112
    v_fmac_f32 v119, v23, v112
    v_exp_f32 v120, v116
    v_mfma_f32_16x16x32_bf16 v[36:39], v[208:211], v[52:55], v[36:39]
    s_waitcnt lgkmcnt(4)
    ds_read_b64_tr_b16 v[52:53], v130 offset:49152
    ds_read_b64_tr_b16 v[54:55], v130 offset:49664
    v_exp_f32 v121, v117
    v_mfma_f32_16x16x32_bf16 v[28:31], a[40:43], v[56:59], v[28:31]
    global_load_dwordx4 a[216:219], v4, s[28:29] offset:-2048
    v_exp_f32 v122, v118
    v_mfma_f32_16x16x32_bf16 v[32:35], a[44:47], v[56:59], v[32:35]
    v_exp_f32 v123, v119
    v_add_f32 v120, 1.0, v120
    v_mfma_f32_16x16x32_bf16 v[36:39], v[212:215], v[56:59], v[36:39]
    s_waitcnt lgkmcnt(4)
    ds_read_b64_tr_b16 v[56:57], v130 offset:50176
    ds_read_b64_tr_b16 v[58:59], v130 offset:50688
    v_add_f32 v121, 1.0, v121
    v_add_f32 v122, 1.0, v122
    v_add_f32 v123, 1.0, v123
    v_mfma_f32_16x16x32_bf16 v[28:31], a[48:51], v[60:63], v[28:31]
    global_load_dwordx4 a[220:223], v4, s[28:29] offset:-1024
    v_rcp_f32 v120, v120
    v_rcp_f32 v121, v121
    v_mfma_f32_16x16x32_bf16 v[32:35], a[52:55], v[60:63], v[32:35]
    v_rcp_f32 v122, v122
    v_mfma_f32_16x16x32_bf16 v[36:39], v[216:219], v[60:63], v[36:39]
    s_waitcnt lgkmcnt(4)
    ds_read_b64_tr_b16 v[60:61], v130 offset:51200
    ds_read_b64_tr_b16 v[62:63], v130 offset:51712
    global_load_dwordx4 a[224:227], v4, s[28:29] offset:0
    v_rcp_f32 v123, v123
    v_mfma_f32_16x16x32_bf16 v[28:31], a[56:59], v[64:67], v[28:31]
    v_mul_f32 v120, v120, v116
    v_mul_f32 v121, v121, v117
    v_mul_f32 v122, v122, v118
    v_mfma_f32_16x16x32_bf16 v[32:35], a[60:63], v[64:67], v[32:35]
    v_mul_f32 v123, v123, v119
    v_cvt_pk_bf16_f32 v134, v120, v121
    v_cvt_pk_bf16_f32 v135, v122, v123
    v_mfma_f32_16x16x32_bf16 v[36:39], v[220:223], v[64:67], v[36:39]
    s_waitcnt lgkmcnt(4)
    ds_read_b64_tr_b16 v[64:65], v130 offset:52224
    ds_read_b64_tr_b16 v[66:67], v130 offset:52736
    buffer_store_dwordx4 v[132:135], v3, s[48:51], s53 offen sc1
    v_mfma_f32_16x16x32_bf16 v[28:31], a[64:67], v[52:55], v[28:31]
    v_mul_f32 v116, v48, v113
    v_mul_f32 v117, v49, v113
    v_mfma_f32_16x16x32_bf16 v[32:35], a[68:71], v[52:55], v[32:35]
    v_mul_f32 v118, v50, v113
    v_mul_f32 v119, v51, v113
    v_mfma_f32_16x16x32_bf16 v[36:39], v[224:227], v[52:55], v[36:39]
    s_waitcnt lgkmcnt(4)
    ds_read_b64_tr_b16 v[52:53], v131 offset:49152
    ds_read_b64_tr_b16 v[54:55], v131 offset:49664
    global_load_dwordx4 a[228:231], v4, s[28:29] offset:1024
    v_fmac_f32 v116, v24, v112
    v_fmac_f32 v117, v25, v112
    v_mfma_f32_16x16x32_bf16 v[28:31], a[72:75], v[56:59], v[28:31]
    v_fmac_f32 v118, v26, v112
    v_fmac_f32 v119, v27, v112
    v_exp_f32 v120, v116
    v_mfma_f32_16x16x32_bf16 v[32:35], a[76:79], v[56:59], v[32:35]
    v_exp_f32 v121, v117
    v_mfma_f32_16x16x32_bf16 v[36:39], v[228:231], v[56:59], v[36:39]
    s_waitcnt lgkmcnt(4)
    ds_read_b64_tr_b16 v[56:57], v131 offset:50176
    ds_read_b64_tr_b16 v[58:59], v131 offset:50688
    global_load_dwordx4 a[232:235], v4, s[28:29] offset:2048
    v_exp_f32 v122, v118
    v_mfma_f32_16x16x32_bf16 v[28:31], v[144:147], v[60:63], v[28:31]
    v_exp_f32 v123, v119
    v_add_f32 v120, 1.0, v120
    v_mfma_f32_16x16x32_bf16 v[32:35], v[148:151], v[60:63], v[32:35]
    v_add_f32 v121, 1.0, v121
    v_add_f32 v122, 1.0, v122
    v_add_f32 v123, 1.0, v123
    v_mfma_f32_16x16x32_bf16 v[36:39], v[232:235], v[60:63], v[36:39]
    s_waitcnt lgkmcnt(4)
    ds_read_b64_tr_b16 v[60:61], v131 offset:51200
    ds_read_b64_tr_b16 v[62:63], v131 offset:51712
    global_load_dwordx4 a[236:239], v4, s[28:29] offset:3072
    v_rcp_f32 v120, v120
    v_rcp_f32 v121, v121
    v_add_u32 v4, 0x2000, v4
    v_mfma_f32_16x16x32_bf16 v[28:31], v[152:155], v[64:67], v[28:31]
    s_barrier
    ds_read_b64 v[114:115], v13 offset:384
    v_rcp_f32 v122, v122
    v_mfma_f32_16x16x32_bf16 v[32:35], v[156:159], v[64:67], v[32:35]
    global_load_dwordx4 a[240:243], v4, s[28:29] offset:-4096
    v_rcp_f32 v123, v123
    v_mfma_f32_16x16x32_bf16 v[36:39], v[236:239], v[64:67], v[36:39]
    s_waitcnt lgkmcnt(5)
    ds_read_b64_tr_b16 v[64:65], v131 offset:52224
    ds_read_b64_tr_b16 v[66:67], v131 offset:52736
    v_mul_f32 v120, v120, v116
    v_mul_f32 v121, v121, v117
    v_mul_f32 v122, v122, v118
    v_mfma_f32_16x16x32_bf16 v[28:31], v[160:163], v[52:55], v[28:31]
    v_mul_f32 v123, v123, v119
    v_cvt_pk_bf16_f32 v136, v120, v121
    v_cvt_pk_bf16_f32 v137, v122, v123
    v_mfma_f32_16x16x32_bf16 v[32:35], v[164:167], v[52:55], v[32:35]
    global_load_dwordx4 a[244:247], v4, s[28:29] offset:-3072
    v_permlane16_swap_b32 v136, v138
    v_permlane16_swap_b32 v137, v139
    v_mfma_f32_16x16x32_bf16 v[36:39], v[240:243], v[52:55], v[36:39]
    s_waitcnt lgkmcnt(5)
    buffer_store_dwordx4 v[136:139], v14, s[48:51], s53 offen sc1
    v_mfma_f32_16x16x32_bf16 v[28:31], v[168:171], v[56:59], v[28:31]
    s_add_u32 s53, s53, 180224
    v_mfma_f32_16x16x32_bf16 v[32:35], v[172:175], v[56:59], v[32:35]
    v_mfma_f32_16x16x32_bf16 v[36:39], v[244:247], v[56:59], v[36:39]
    s_waitcnt lgkmcnt(3)
    v_mfma_f32_16x16x32_bf16 v[28:31], v[176:179], v[60:63], v[28:31]
    v_mfma_f32_16x16x32_bf16 v[32:35], v[180:183], v[60:63], v[32:35]
    v_mfma_f32_16x16x32_bf16 v[36:39], v[248:251], v[60:63], v[36:39]
    s_waitcnt lgkmcnt(0)
    v_mfma_f32_16x16x32_bf16 v[28:31], v[184:187], v[64:67], v[28:31]
    global_load_dwordx4 a[248:251], v4, s[28:29] offset:-2048
    v_mfma_f32_16x16x32_bf16 v[32:35], v[188:191], v[64:67], v[32:35]
    v_mfma_f32_16x16x32_bf16 v[36:39], v[252:255], v[64:67], v[36:39]
    v_pk_mul_f32 v[116:117], v[40:41], v[114:115] op_sel:[0,1] op_sel_hi:[1,1]
    v_pk_mul_f32 v[118:119], v[42:43], v[114:115] op_sel:[0,1] op_sel_hi:[1,1]
    s_nop 2
    v_pk_fma_f32 v[116:117], v[28:29], v[114:115], v[116:117] op_sel_hi:[1,0,1]
    global_load_dwordx4 a[252:255], v4, s[28:29] offset:-1024
    v_pk_fma_f32 v[118:119], v[30:31], v[114:115], v[118:119] op_sel_hi:[1,0,1]
    v_exp_f32 v120, v116
    v_exp_f32 v121, v117
    v_exp_f32 v122, v118
    v_exp_f32 v123, v119
    v_pk_add_f32 v[120:121], v[120:121], 1.0 op_sel_hi:[1,0]
    v_pk_add_f32 v[122:123], v[122:123], 1.0 op_sel_hi:[1,0]
    v_rcp_f32 v120, v120
    global_load_dwordx4 v[68:71], v5, s[28:29] offset:-4096 sc1
    v_rcp_f32 v121, v121
    v_rcp_f32 v122, v122
    v_rcp_f32 v123, v123
    v_pk_mul_f32 v[120:121], v[120:121], v[116:117]
    v_pk_mul_f32 v[122:123], v[122:123], v[118:119]
    v_cvt_pk_bf16_f32 v132, v120, v121
    v_cvt_pk_bf16_f32 v133, v122, v123
    v_pk_mul_f32 v[116:117], v[44:45], v[114:115] op_sel:[0,1] op_sel_hi:[1,1]
    global_load_dwordx4 v[72:75], v5, s[28:29] offset:-3072 sc1
    v_pk_mul_f32 v[118:119], v[46:47], v[114:115] op_sel:[0,1] op_sel_hi:[1,1]
    v_pk_fma_f32 v[116:117], v[32:33], v[114:115], v[116:117] op_sel_hi:[1,0,1]
    v_pk_fma_f32 v[118:119], v[34:35], v[114:115], v[118:119] op_sel_hi:[1,0,1]
    v_exp_f32 v120, v116
    v_exp_f32 v121, v117
    v_exp_f32 v122, v118
    v_exp_f32 v123, v119
    v_pk_add_f32 v[120:121], v[120:121], 1.0 op_sel_hi:[1,0]
    global_load_dwordx4 v[76:79], v5, s[28:29] offset:-2048 sc1
    v_pk_add_f32 v[122:123], v[122:123], 1.0 op_sel_hi:[1,0]
    v_rcp_f32 v120, v120
    v_rcp_f32 v121, v121
    v_rcp_f32 v122, v122
    v_rcp_f32 v123, v123
    v_pk_mul_f32 v[120:121], v[120:121], v[116:117]
    v_pk_mul_f32 v[122:123], v[122:123], v[118:119]
    v_cvt_pk_bf16_f32 v134, v120, v121
    global_load_dwordx4 v[80:83], v5, s[28:29] offset:-1024 sc1
    v_cvt_pk_bf16_f32 v135, v122, v123
    buffer_store_dwordx4 v[132:135], v3, s[48:51], s53 offen sc1
    v_pk_mul_f32 v[116:117], v[48:49], v[114:115] op_sel:[0,1] op_sel_hi:[1,1]
    v_pk_mul_f32 v[118:119], v[50:51], v[114:115] op_sel:[0,1] op_sel_hi:[1,1]
    v_pk_fma_f32 v[116:117], v[36:37], v[114:115], v[116:117] op_sel_hi:[1,0,1]
    v_pk_fma_f32 v[118:119], v[38:39], v[114:115], v[118:119] op_sel_hi:[1,0,1]
    v_exp_f32 v120, v116
    v_exp_f32 v121, v117
    v_exp_f32 v122, v118
    v_exp_f32 v123, v119
    v_pk_add_f32 v[120:121], v[120:121], 1.0 op_sel_hi:[1,0]
    v_pk_add_f32 v[122:123], v[122:123], 1.0 op_sel_hi:[1,0]
    v_rcp_f32 v120, v120
    v_rcp_f32 v121, v121
    v_rcp_f32 v122, v122
    global_load_dwordx4 v[84:87], v5, s[28:29] offset:0 sc1
    v_rcp_f32 v123, v123
    v_pk_mul_f32 v[120:121], v[120:121], v[116:117]
    v_pk_mul_f32 v[122:123], v[122:123], v[118:119]
    v_cvt_pk_bf16_f32 v136, v120, v121
    v_cvt_pk_bf16_f32 v137, v122, v123
    s_nop 0
    v_permlane16_swap_b32 v136, v138
    v_permlane16_swap_b32 v137, v139
    buffer_store_dwordx4 v[136:139], v14, s[48:51], s53 offen sc1
    global_load_dwordx4 v[88:91], v5, s[28:29] offset:1024 sc1
    global_load_dwordx4 v[92:95], v5, s[28:29] offset:2048 sc1
    global_load_dwordx4 v[96:99], v5, s[28:29] offset:3072 sc1
    v_add_u32 v5, 0x1000, v5
    global_load_dwordx4 v[100:103], v5, s[28:29] offset:0 sc1
    s_branch L_g2
L_g1b:
    v_mov_b32 v48, s47
    v_mov_b32 v49, s47
    v_mov_b32 v50, s47
    v_mov_b32 v51, s47
    s_mov_b32 s12, 0x22222222
    s_mov_b32 s13, 0x22222222
    s_mov_b32 s14, 0x44444444
    s_mov_b32 s15, 0x44444444
    s_mov_b32 s16, 0x88888888
    s_mov_b32 s17, 0x88888888
    s_mov_b32 s18, 0x3b000000
    s_waitcnt vmcnt(7)
    ds_read_b64_tr_b16 v[192:193], v128 offset:0
    ds_read_b64_tr_b16 v[194:195], v128 offset:512
    ds_read_b64_tr_b16 v[196:197], v128 offset:1024
    ds_read_b64_tr_b16 v[198:199], v128 offset:1536
    ds_read_b64_tr_b16 v[200:201], v128 offset:2048
    ds_read_b64_tr_b16 v[202:203], v128 offset:2560
    ds_read_b64_tr_b16 v[204:205], v128 offset:3072
    ds_read_b64_tr_b16 v[206:207], v128 offset:3584
    global_load_dwordx4 v[144:147], v32, s[28:29] offset:2048
    global_load_dwordx4 v[148:151], v33, s[28:29] offset:2048
    global_load_dwordx4 v[152:155], v32, s[28:29] offset:3072
    s_waitcnt lgkmcnt(6)
    v_mfma_f32_16x16x32_bf16 v[24:27], v[48:51], v[192:195], 0
    ds_read_b64_tr_b16 v[208:209], v129 offset:0
    ds_read_b64_tr_b16 v[210:211], v129 offset:512
    global_load_dwordx4 v[156:159], v33, s[28:29] offset:3072
    v_mfma_f32_16x16x32_bf16 v[36:39], v[192:195], v[192:195], 0
    s_waitcnt lgkmcnt(6)
    ds_read_b64_tr_b16 v[212:213], v129 offset:1024
    ds_read_b64_tr_b16 v[214:215], v129 offset:1536
    v_mfma_f32_16x16x32_bf16 v[24:27], v[48:51], v[196:199], v[24:27]
    ds_read_b64_tr_b16 v[216:217], v129 offset:2048
    ds_read_b64_tr_b16 v[218:219], v129 offset:2560
    v_mfma_f32_16x16x32_bf16 v[36:39], v[196:199], v[196:199], v[36:39]
    s_waitcnt lgkmcnt(8)
    ds_read_b64_tr_b16 v[220:221], v129 offset:3072
    ds_read_b64_tr_b16 v[222:223], v129 offset:3584
    v_add_u32 v32, s35, v32
    global_load_dwordx4 v[160:163], v32, s[28:29] offset:0
    v_mfma_f32_16x16x32_bf16 v[24:27], v[48:51], v[200:203], v[24:27]
    ds_read_b64_tr_b16 v[224:225], v130 offset:0
    ds_read_b64_tr_b16 v[226:227], v130 offset:512
    v_mfma_f32_16x16x32_bf16 v[36:39], v[200:203], v[200:203], v[36:39]
    s_waitcnt lgkmcnt(10)
    ds_read_b64_tr_b16 v[228:229], v130 offset:1024
    v_mfma_f32_16x16x32_bf16 v[24:27], v[48:51], v[204:207], v[24:27]
    ds_read_b64_tr_b16 v[230:231], v130 offset:1536
    v_mfma_f32_16x16x32_bf16 v[36:39], v[204:207], v[204:207], v[36:39]
    s_waitcnt lgkmcnt(10)
    ds_read_b64_tr_b16 v[232:233], v130 offset:2048
    ds_read_b64_tr_b16 v[234:235], v130 offset:2560
    v_add_u32 v33, s35, v33
    global_load_dwordx4 v[164:167], v33, s[28:29] offset:0
    v_mfma_f32_16x16x32_bf16 v[24:27], v[48:51], v[208:211], v[24:27]
    ds_read_b64_tr_b16 v[236:237], v130 offset:3072
    ds_read_b64_tr_b16 v[238:239], v130 offset:3584
    v_mfma_f32_16x16x32_bf16 v[36:39], v[208:211], v[208:211], v[36:39]
    s_waitcnt lgkmcnt(8)
    ds_read_b64_tr_b16 v[240:241], v131 offset:0
    ds_read_b64_tr_b16 v[242:243], v131 offset:512
    v_mfma_f32_16x16x32_bf16 v[24:27], v[48:51], v[212:215], v[24:27]
    ds_read_b64_tr_b16 v[244:245], v131 offset:1024
    ds_read_b64_tr_b16 v[246:247], v131 offset:1536
    global_load_dwordx4 v[168:171], v32, s[28:29] offset:1024
    v_add_u32 v11, 0x4000, v11
    v_mfma_f32_16x16x32_bf16 v[36:39], v[212:215], v[212:215], v[36:39]
    ds_read_b64_tr_b16 v[248:249], v131 offset:2048
    ds_read_b64_tr_b16 v[250:251], v131 offset:2560
    v_mfma_f32_16x16x32_bf16 v[24:27], v[48:51], v[216:219], v[24:27]
    s_waitcnt lgkmcnt(8)
    ds_read_b64_tr_b16 v[252:253], v131 offset:3072
    ds_read_b64_tr_b16 v[254:255], v131 offset:3584
    v_mfma_f32_16x16x32_bf16 v[36:39], v[216:219], v[216:219], v[36:39]
    v_mfma_f32_16x16x32_bf16 v[24:27], v[48:51], v[220:223], v[24:27]
    global_load_dwordx4 v[172:175], v33, s[28:29] offset:1024
    v_mfma_f32_16x16x32_bf16 v[36:39], v[220:223], v[220:223], v[36:39]
    v_mfma_f32_16x16x32_bf16 v[24:27], v[48:51], v[224:227], v[24:27]
    v_mfma_f32_16x16x32_bf16 v[36:39], v[224:227], v[224:227], v[36:39]
    v_mfma_f32_16x16x32_bf16 v[24:27], v[48:51], v[228:231], v[24:27]
    global_load_dwordx4 v[176:179], v32, s[28:29] offset:2048
    v_mfma_f32_16x16x32_bf16 v[36:39], v[228:231], v[228:231], v[36:39]
    v_mfma_f32_16x16x32_bf16 v[24:27], v[48:51], v[232:235], v[24:27]
    v_mfma_f32_16x16x32_bf16 v[36:39], v[232:235], v[232:235], v[36:39]
    s_waitcnt lgkmcnt(8)
    v_mfma_f32_16x16x32_bf16 v[24:27], v[48:51], v[236:239], v[24:27]
    v_mfma_f32_16x16x32_bf16 v[36:39], v[236:239], v[236:239], v[36:39]
    s_waitcnt lgkmcnt(6)
    global_load_dwordx4 v[180:183], v33, s[28:29] offset:2048
    v_mfma_f32_16x16x32_bf16 v[24:27], v[48:51], v[240:243], v[24:27]
    v_mfma_f32_16x16x32_bf16 v[36:39], v[240:243], v[240:243], v[36:39]
    s_waitcnt lgkmcnt(4)
    v_mfma_f32_16x16x32_bf16 v[24:27], v[48:51], v[244:247], v[24:27]
    v_mfma_f32_16x16x32_bf16 v[36:39], v[244:247], v[244:247], v[36:39]
    s_waitcnt lgkmcnt(2)
    global_load_dwordx4 v[184:187], v32, s[28:29] offset:3072
    v_mfma_f32_16x16x32_bf16 v[24:27], v[48:51], v[248:251], v[24:27]
    v_mfma_f32_16x16x32_bf16 v[36:39], v[248:251], v[248:251], v[36:39]
    s_waitcnt lgkmcnt(0)
    v_mfma_f32_16x16x32_bf16 v[24:27], v[48:51], v[252:255], v[24:27]
    v_mfma_f32_16x16x32_bf16 v[36:39], v[252:255], v[252:255], v[36:39]
    global_load_dwordx4 v[188:191], v33, s[28:29] offset:3072
    v_mfma_f32_16x16x32_bf16 v[16:19], a[0:3], v[192:195], 0
    v_mfma_f32_16x16x32_bf16 v[20:23], a[4:7], v[192:195], 0
    v_mfma_f32_16x16x32_bf16 v[16:19], a[8:11], v[196:199], v[16:19]
    v_mfma_f32_16x16x32_bf16 v[20:23], a[12:15], v[196:199], v[20:23]
    global_load_dwordx4 v[68:71], v11, s[28:29] offset:0 sc1
    v_mfma_f32_16x16x32_bf16 v[16:19], a[16:19], v[200:203], v[16:19]
    v_mfma_f32_16x16x32_bf16 v[20:23], a[20:23], v[200:203], v[20:23]
    v_cndmask_b32 v140, v36, v37, s[12:13]
    v_mul_f32 v141, 0xbb000000, v24
    v_cndmask_b32 v140, v140, v38, s[14:15]
    v_mul_f32 v142, v141, v141
    v_cndmask_b32 v140, v140, v39, s[16:17]
    v_fma_f32 v140, v140, s18, -v142
    v_max_f32 v140, 0, v140
    v_add_f32 v140, 0x3727c5ac, v140
    v_rsq_f32 v140, v140
    v_mfma_f32_16x16x32_bf16 v[16:19], a[24:27], v[204:207], v[16:19]
    global_load_dwordx4 v[72:75], v11, s[28:29] offset:1024 sc1
    v_mul_f32 v140, 0xbfb8aa3b, v140
    v_mul_f32 v141, v141, v140
    v_mfma_f32_16x16x32_bf16 v[20:23], a[28:31], v[204:207], v[20:23]
    ds_write_b64 v14, v[140:141] offset:0
    v_mfma_f32_16x16x32_bf16 v[16:19], a[32:35], v[208:211], v[16:19]
    v_mfma_f32_16x16x32_bf16 v[20:23], a[36:39], v[208:211], v[20:23]
    global_load_dwordx4 v[76:79], v11, s[28:29] offset:2048 sc1
    v_mfma_f32_16x16x32_bf16 v[16:19], a[40:43], v[212:215], v[16:19]
    v_mfma_f32_16x16x32_bf16 v[20:23], a[44:47], v[212:215], v[20:23]
    v_mfma_f32_16x16x32_bf16 v[16:19], a[48:51], v[216:219], v[16:19]
    v_mfma_f32_16x16x32_bf16 v[20:23], a[52:55], v[216:219], v[20:23]
    s_waitcnt vmcnt(19)
    global_load_dwordx4 v[80:83], v11, s[28:29] offset:3072 sc1
    v_max3_u32 v100, v84, v85, v86
    v_max3_u32 v100, v100, v87, v88
    v_max3_u32 v100, v100, v89, v90
    v_max3_u32 v100, v100, v91, v92
    v_max3_u32 v100, v100, v93, v94
    v_max3_u32 v100, v100, v95, v96
    v_max3_u32 v100, v100, v97, v98
    v_max_u32 v100, v100, v99
    v_cmp_eq_u32 vcc, -1, v100
    v_mfma_f32_16x16x32_bf16 v[16:19], a[56:59], v[220:223], v[16:19]
    s_cbranch_vccnz L_rh1b
L_bh1b:
    ds_write_b128 v12, v[84:87] offset:16384
    ds_write_b128 v12, v[88:91] offset:17408
    ds_write_b128 v12, v[92:95] offset:18432
    ds_write_b128 v12, v[96:99] offset:19456
    global_load_dword v125, v124, s[28:29] sc1
    v_mfma_f32_16x16x32_bf16 v[20:23], a[60:63], v[220:223], v[20:23]
    v_mfma_f32_16x16x32_bf16 v[16:19], a[64:67], v[224:227], v[16:19]
    v_mfma_f32_16x16x32_bf16 v[20:23], a[68:71], v[224:227], v[20:23]
    s_waitcnt vmcnt(18)
    v_mfma_f32_16x16x32_bf16 v[16:19], a[72:75], v[228:231], v[16:19]
    s_waitcnt vmcnt(17)
    v_mfma_f32_16x16x32_bf16 v[20:23], a[76:79], v[228:231], v[20:23]
    s_waitcnt vmcnt(16)
    v_mfma_f32_16x16x32_bf16 v[16:19], v[144:147], v[232:235], v[16:19]
    s_waitcnt vmcnt(15)
    v_mfma_f32_16x16x32_bf16 v[20:23], v[148:151], v[232:235], v[20:23]
    s_waitcnt vmcnt(14) lgkmcnt(0)
    s_barrier
    ds_read_b64_tr_b16 v[192:193], v128 offset:16384
    ds_read_b64_tr_b16 v[194:195], v128 offset:16896
    ds_read_b64 v[112:113], v13 offset:0
    v_mfma_f32_16x16x32_bf16 v[16:19], v[152:155], v[236:239], v[16:19]
    s_waitcnt vmcnt(13)
    ds_read_b64_tr_b16 v[196:197], v128 offset:17408
    ds_read_b64_tr_b16 v[198:199], v128 offset:17920
    v_mfma_f32_16x16x32_bf16 v[20:23], v[156:159], v[236:239], v[20:23]
    s_waitcnt vmcnt(12)
    ds_read_b64_tr_b16 v[200:201], v128 offset:18432
    ds_read_b64_tr_b16 v[202:203], v128 offset:18944
    v_mfma_f32_16x16x32_bf16 v[16:19], v[160:163], v[240:243], v[16:19]
    s_waitcnt vmcnt(11)
    ds_read_b64_tr_b16 v[204:205], v128 offset:19456
    ds_read_b64_tr_b16 v[206:207], v128 offset:19968
    v_mfma_f32_16x16x32_bf16 v[20:23], v[164:167], v[240:243], v[20:23]
    s_waitcnt vmcnt(10)
    ds_read_b64_tr_b16 v[208:209], v129 offset:16384
    v_mfma_f32_16x16x32_bf16 v[16:19], v[168:171], v[244:247], v[16:19]
    s_waitcnt vmcnt(9)
    v_mfma_f32_16x16x32_bf16 v[20:23], v[172:175], v[244:247], v[20:23]
    s_waitcnt vmcnt(8)
    ds_read_b64_tr_b16 v[210:211], v129 offset:16896
    ds_read_b64_tr_b16 v[212:213], v129 offset:17408
    v_mfma_f32_16x16x32_bf16 v[16:19], v[176:179], v[248:251], v[16:19]
    s_waitcnt vmcnt(7)
    ds_read_b64_tr_b16 v[214:215], v129 offset:17920
    ds_read_b64_tr_b16 v[216:217], v129 offset:18432
    v_mfma_f32_16x16x32_bf16 v[20:23], v[180:183], v[248:251], v[20:23]
    s_waitcnt vmcnt(6) lgkmcnt(2)
    ds_read_b64_tr_b16 v[218:219], v129 offset:18944
    ds_read_b64_tr_b16 v[220:221], v129 offset:19456
    v_mfma_f32_16x16x32_bf16 v[16:19], v[184:187], v[252:255], v[16:19]
    s_waitcnt vmcnt(5)
    ds_read_b64_tr_b16 v[222:223], v129 offset:19968
    ds_read_b64_tr_b16 v[224:225], v130 offset:16384
    v_mfma_f32_16x16x32_bf16 v[20:23], v[188:191], v[252:255], v[20:23]
    ds_read_b64_tr_b16 v[226:227], v130 offset:16896
    ds_read_b64_tr_b16 v[228:229], v130 offset:17408
    v_mul_f32 v116, v40, v113
    v_mul_f32 v117, v41, v113
    v_mfma_f32_16x16x32_bf16 v[24:27], v[48:51], v[192:195], 0
    ds_read_b64_tr_b16 v[230:231], v130 offset:17920
    ds_read_b64_tr_b16 v[232:233], v130 offset:18432
    v_mul_f32 v118, v42, v113
    v_mfma_f32_16x16x32_bf16 v[36:39], v[192:195], v[192:195], 0
    ds_read_b64_tr_b16 v[234:235], v130 offset:18944
    ds_read_b64_tr_b16 v[236:237], v130 offset:19456
    v_mul_f32 v119, v43, v113
    v_fmac_f32 v116, v16, v112
    v_mfma_f32_16x16x32_bf16 v[24:27], v[48:51], v[196:199], v[24:27]
    ds_read_b64_tr_b16 v[238:239], v130 offset:19968
    ds_read_b64_tr_b16 v[240:241], v131 offset:16384
    v_fmac_f32 v117, v17, v112
    v_mfma_f32_16x16x32_bf16 v[36:39], v[196:199], v[196:199], v[36:39]
    s_waitcnt lgkmcnt(8)
    ds_read_b64_tr_b16 v[242:243], v131 offset:16896
    ds_read_b64_tr_b16 v[244:245], v131 offset:17408
    v_fmac_f32 v118, v18, v112
    v_mfma_f32_16x16x32_bf16 v[24:27], v[48:51], v[200:203], v[24:27]
    ds_read_b64_tr_b16 v[246:247], v131 offset:17920
    ds_read_b64_tr_b16 v[248:249], v131 offset:18432
    v_fmac_f32 v119, v19, v112
    v_exp_f32 v120, v116
    v_mfma_f32_16x16x32_bf16 v[36:39], v[200:203], v[200:203], v[36:39]
    ds_read_b64_tr_b16 v[250:251], v131 offset:18944
    ds_read_b64_tr_b16 v[252:253], v131 offset:19456
    v_mfma_f32_16x16x32_bf16 v[24:27], v[48:51], v[204:207], v[24:27]
    ds_read_b64_tr_b16 v[254:255], v131 offset:19968
    v_exp_f32 v121, v117
    v_mfma_f32_16x16x32_bf16 v[36:39], v[204:207], v[204:207], v[36:39]
    v_exp_f32 v122, v118
    v_mfma_f32_16x16x32_bf16 v[24:27], v[48:51], v[208:211], v[24:27]
    v_exp_f32 v123, v119
    v_mfma_f32_16x16x32_bf16 v[36:39], v[208:211], v[208:211], v[36:39]
    v_add_f32 v120, 1.0, v120
    v_add_f32 v121, 1.0, v121
    v_mfma_f32_16x16x32_bf16 v[24:27], v[48:51], v[212:215], v[24:27]
    v_add_u32 v11, 0x4000, v11
    v_add_f32 v122, 1.0, v122
    v_mfma_f32_16x16x32_bf16 v[36:39], v[212:215], v[212:215], v[36:39]
    global_load_dwordx4 v[84:87], v11, s[28:29] offset:0 sc1
    global_load_dwordx4 v[88:91], v11, s[28:29] offset:1024 sc1
    global_load_dwordx4 v[92:95], v11, s[28:29] offset:2048 sc1
    global_load_dwordx4 v[96:99], v11, s[28:29] offset:3072 sc1
    v_mfma_f32_16x16x32_bf16 v[24:27], v[48:51], v[216:219], v[24:27]
    v_add_f32 v123, 1.0, v123
    v_mfma_f32_16x16x32_bf16 v[36:39], v[216:219], v[216:219], v[36:39]
    s_waitcnt vmcnt(4)
    v_rcp_f32 v120, v120
    v_cmp_ne_u32 vcc, s43, v125
    v_mfma_f32_16x16x32_bf16 v[24:27], v[48:51], v[220:223], v[24:27]
    s_cbranch_vccnz L_rw2b
L_bw2b:
    v_rcp_f32 v121, v121
    v_mfma_f32_16x16x32_bf16 v[36:39], v[220:223], v[220:223], v[36:39]
    s_waitcnt lgkmcnt(14)
    global_load_dwordx4 a[80:83], v4, s[28:29] offset:-4096
    v_mfma_f32_16x16x32_bf16 v[24:27], v[48:51], v[224:227], v[24:27]
    v_rcp_f32 v122, v122
    v_mfma_f32_16x16x32_bf16 v[36:39], v[224:227], v[224:227], v[36:39]
    s_waitcnt lgkmcnt(12)
    v_rcp_f32 v123, v123
    v_mfma_f32_16x16x32_bf16 v[24:27], v[48:51], v[228:231], v[24:27]
    v_mul_f32 v120, v120, v116
    v_mul_f32 v121, v121, v117
    v_mfma_f32_16x16x32_bf16 v[36:39], v[228:231], v[228:231], v[36:39]
    s_waitcnt lgkmcnt(10)
    global_load_dwordx4 a[84:87], v4, s[28:29] offset:-3072
    v_mul_f32 v122, v122, v118
    v_mfma_f32_16x16x32_bf16 v[24:27], v[48:51], v[232:235], v[24:27]
    v_mul_f32 v123, v123, v119
    v_cvt_pk_bf16_f32 v132, v120, v121
    v_mfma_f32_16x16x32_bf16 v[36:39], v[232:235], v[232:235], v[36:39]
    s_waitcnt lgkmcnt(8)
    v_cvt_pk_bf16_f32 v133, v122, v123
    v_mul_f32 v116, v44, v113
    v_mfma_f32_16x16x32_bf16 v[24:27], v[48:51], v[236:239], v[24:27]
    v_mul_f32 v117, v45, v113
    v_mul_f32 v118, v46, v113
    v_mfma_f32_16x16x32_bf16 v[36:39], v[236:239], v[236:239], v[36:39]
    s_waitcnt lgkmcnt(6)
    global_load_dwordx4 a[88:91], v4, s[28:29] offset:-2048
    v_mul_f32 v119, v47, v113
    v_mfma_f32_16x16x32_bf16 v[24:27], v[48:51], v[240:243], v[24:27]
    v_max3_u32 v100, v68, v69, v70
    v_max3_u32 v100, v100, v71, v72
    v_max3_u32 v100, v100, v73, v74
    v_max3_u32 v100, v100, v75, v76
    v_max3_u32 v100, v100, v77, v78
    v_max3_u32 v100, v100, v79, v80
    v_max3_u32 v100, v100, v81, v82
    v_max_u32 v100, v100, v83
    v_cmp_eq_u32 vcc, -1, v100
    v_mfma_f32_16x16x32_bf16 v[36:39], v[240:243], v[240:243], v[36:39]
    s_waitcnt lgkmcnt(4)
    s_cbranch_vccnz L_rh2b
L_bh2b:
    ds_write_b128 v12, v[68:71] offset:32768
    ds_write_b128 v12, v[72:75] offset:33792
    ds_write_b128 v12, v[76:79] offset:34816
    ds_write_b128 v12, v[80:83] offset:35840
    global_load_dwordx4 a[92:95], v4, s[28:29] offset:-1024
    global_load_dwordx4 a[96:99], v4, s[28:29] offset:0
    v_mfma_f32_16x16x32_bf16 v[24:27], v[48:51], v[244:247], v[24:27]
    v_fmac_f32 v116, v20, v112
    v_fmac_f32 v117, v21, v112
    v_mfma_f32_16x16x32_bf16 v[36:39], v[244:247], v[244:247], v[36:39]
    s_waitcnt lgkmcnt(6)
    v_fmac_f32 v118, v22, v112
    v_fmac_f32 v119, v23, v112
    v_mfma_f32_16x16x32_bf16 v[24:27], v[48:51], v[248:251], v[24:27]
    global_load_dwordx4 a[100:103], v4, s[28:29] offset:1024
    v_mfma_f32_16x16x32_bf16 v[36:39], v[248:251], v[248:251], v[36:39]
    s_waitcnt lgkmcnt(4)
    v_exp_f32 v120, v116
    v_mfma_f32_16x16x32_bf16 v[24:27], v[48:51], v[252:255], v[24:27]
    v_exp_f32 v121, v117
    v_mfma_f32_16x16x32_bf16 v[36:39], v[252:255], v[252:255], v[36:39]
    v_exp_f32 v122, v118
    v_mfma_f32_16x16x32_bf16 v[28:31], a[0:3], v[192:195], 0
    global_load_dwordx4 a[104:107], v4, s[28:29] offset:2048
    v_mfma_f32_16x16x32_bf16 v[32:35], a[4:7], v[192:195], 0
    v_exp_f32 v123, v119
    v_mfma_f32_16x16x32_bf16 v[28:31], a[8:11], v[196:199], v[28:31]
    v_add_f32 v120, 1.0, v120
    v_add_f32 v121, 1.0, v121
    v_mfma_f32_16x16x32_bf16 v[32:35], a[12:15], v[196:199], v[32:35]
    v_cndmask_b32 v140, v36, v37, s[12:13]
    v_mul_f32 v141, 0xbb000000, v24
    v_cndmask_b32 v140, v140, v38, s[14:15]
    v_mul_f32 v142, v141, v141
    v_cndmask_b32 v140, v140, v39, s[16:17]
    v_fma_f32 v140, v140, s18, -v142
    v_max_f32 v140, 0, v140
    v_add_f32 v140, 0x3727c5ac, v140
    v_rsq_f32 v140, v140
    v_mfma_f32_16x16x32_bf16 v[28:31], a[16:19], v[200:203], v[28:31]
    global_load_dwordx4 a[108:111], v4, s[28:29] offset:3072
    v_mul_f32 v140, 0xbfb8aa3b, v140
    v_mul_f32 v141, v141, v140
    v_add_f32 v122, 1.0, v122
    v_add_u32 v4, 0x2000, v4
    v_mfma_f32_16x16x32_bf16 v[32:35], a[20:23], v[200:203], v[32:35]
    ds_write_b64 v14, v[140:141] offset:128
    global_load_dwordx4 a[112:115], v4, s[28:29] offset:-4096
    v_add_f32 v123, 1.0, v123
    v_mfma_f32_16x16x32_bf16 v[28:31], a[24:27], v[204:207], v[28:31]
    v_rcp_f32 v120, v120
    v_mfma_f32_16x16x32_bf16 v[32:35], a[28:31], v[204:207], v[32:35]
    v_rcp_f32 v121, v121
    v_mfma_f32_16x16x32_bf16 v[28:31], a[32:35], v[208:211], v[28:31]
    v_rcp_f32 v122, v122
    v_mfma_f32_16x16x32_bf16 v[32:35], a[36:39], v[208:211], v[32:35]
    global_load_dwordx4 a[116:119], v4, s[28:29] offset:-3072
    v_mfma_f32_16x16x32_bf16 v[28:31], a[40:43], v[212:215], v[28:31]
    v_rcp_f32 v123, v123
    v_mfma_f32_16x16x32_bf16 v[32:35], a[44:47], v[212:215], v[32:35]
    v_mul_f32 v120, v120, v116
    v_mul_f32 v121, v121, v117
    v_mfma_f32_16x16x32_bf16 v[28:31], a[48:51], v[216:219], v[28:31]
    v_mul_f32 v122, v122, v118
    v_mul_f32 v123, v123, v119
    v_mfma_f32_16x16x32_bf16 v[32:35], a[52:55], v[216:219], v[32:35]
    global_load_dwordx4 a[120:123], v4, s[28:29] offset:-2048
    v_cvt_pk_bf16_f32 v134, v120, v121
    v_mfma_f32_16x16x32_bf16 v[28:31], a[56:59], v[220:223], v[28:31]
    v_cvt_pk_bf16_f32 v135, v122, v123
    v_mfma_f32_16x16x32_bf16 v[32:35], a[60:63], v[220:223], v[32:35]
    v_mfma_f32_16x16x32_bf16 v[28:31], a[64:67], v[224:227], v[28:31]
    s_waitcnt lgkmcnt(0)
    s_barrier
    ds_read_b64_tr_b16 v[192:193], v128 offset:32768
    ds_read_b64_tr_b16 v[194:195], v128 offset:33280
    ds_read_b64 v[114:115], v13 offset:128
    buffer_store_dwordx4 v[132:135], v3, s[48:51], s53 offen sc1
    v_mfma_f32_16x16x32_bf16 v[32:35], a[68:71], v[224:227], v[32:35]
    ds_read_b64_tr_b16 v[196:197], v128 offset:33792
    ds_read_b64_tr_b16 v[198:199], v128 offset:34304
    s_add_u32 s53, s53, 180224
    v_mfma_f32_16x16x32_bf16 v[28:31], a[72:75], v[228:231], v[28:31]
    ds_read_b64_tr_b16 v[200:201], v128 offset:34816
    ds_read_b64_tr_b16 v[202:203], v128 offset:35328
    v_mfma_f32_16x16x32_bf16 v[32:35], a[76:79], v[228:231], v[32:35]
    ds_read_b64_tr_b16 v[204:205], v128 offset:35840
    ds_read_b64_tr_b16 v[206:207], v128 offset:36352
    global_load_dwordx4 a[124:127], v4, s[28:29] offset:-1024
    v_mfma_f32_16x16x32_bf16 v[28:31], v[144:147], v[232:235], v[28:31]
    ds_read_b64_tr_b16 v[208:209], v129 offset:32768
    ds_read_b64_tr_b16 v[210:211], v129 offset:33280
    v_mfma_f32_16x16x32_bf16 v[32:35], v[148:151], v[232:235], v[32:35]
    ds_read_b64_tr_b16 v[212:213], v129 offset:33792
    v_mfma_f32_16x16x32_bf16 v[28:31], v[152:155], v[236:239], v[28:31]
    v_mfma_f32_16x16x32_bf16 v[32:35], v[156:159], v[236:239], v[32:35]
    ds_read_b64_tr_b16 v[214:215], v129 offset:34304
    ds_read_b64_tr_b16 v[216:217], v129 offset:34816
    global_load_dwordx4 a[128:131], v4, s[28:29] offset:0
    v_mfma_f32_16x16x32_bf16 v[28:31], v[160:163], v[240:243], v[28:31]
    s_waitcnt lgkmcnt(7)
    ds_read_b64_tr_b16 v[218:219], v129 offset:35328
    ds_read_b64_tr_b16 v[220:221], v129 offset:35840
    v_mfma_f32_16x16x32_bf16 v[32:35], v[164:167], v[240:243], v[32:35]
    ds_read_b64_tr_b16 v[222:223], v129 offset:36352
    ds_read_b64_tr_b16 v[224:225], v130 offset:32768
    v_mfma_f32_16x16x32_bf16 v[28:31], v[168:171], v[244:247], v[28:31]
    ds_read_b64_tr_b16 v[226:227], v130 offset:33280
    ds_read_b64_tr_b16 v[228:229], v130 offset:33792
    v_mfma_f32_16x16x32_bf16 v[32:35], v[172:175], v[244:247], v[32:35]
    ds_read_b64_tr_b16 v[230:231], v130 offset:34304
    ds_read_b64_tr_b16 v[232:233], v130 offset:34816
    global_load_dwordx4 a[132:135], v4, s[28:29] offset:1024
    v_mfma_f32_16x16x32_bf16 v[28:31], v[176:179], v[248:251], v[28:31]
    v_mfma_f32_16x16x32_bf16 v[32:35], v[180:183], v[248:251], v[32:35]
    s_waitcnt lgkmcnt(8)
    ds_read_b64_tr_b16 v[234:235], v130 offset:35328
    ds_read_b64_tr_b16 v[236:237], v130 offset:35840
    v_mfma_f32_16x16x32_bf16 v[28:31], v[184:187], v[252:255], v[28:31]
    ds_read_b64_tr_b16 v[238:239], v130 offset:36352
    ds_read_b64_tr_b16 v[240:241], v131 offset:32768
    v_mfma_f32_16x16x32_bf16 v[32:35], v[188:191], v[252:255], v[32:35]
    ds_read_b64_tr_b16 v[242:243], v131 offset:33280
    ds_read_b64_tr_b16 v[244:245], v131 offset:33792
    global_load_dwordx4 a[136:139], v4, s[28:29] offset:2048
    v_mul_f32 v116, v40, v115
    v_mul_f32 v117, v41, v115
    v_mfma_f32_16x16x32_bf16 v[24:27], v[48:51], v[192:195], 0
    s_waitcnt lgkmcnt(7)
    ds_read_b64_tr_b16 v[246:247], v131 offset:34304
    ds_read_b64_tr_b16 v[248:249], v131 offset:34816
    v_mul_f32 v118, v42, v115
    v_mfma_f32_16x16x32_bf16 v[36:39], v[192:195], v[192:195], 0
    ds_read_b64_tr_b16 v[250:251], v131 offset:35328
    ds_read_b64_tr_b16 v[252:253], v131 offset:35840
    v_mul_f32 v119, v43, v115
    v_fmac_f32 v116, v28, v114
    v_mfma_f32_16x16x32_bf16 v[24:27], v[48:51], v[196:199], v[24:27]
    ds_read_b64_tr_b16 v[254:255], v131 offset:36352
    global_load_dwordx4 a[140:143], v4, s[28:29] offset:3072
    v_fmac_f32 v117, v29, v114
    v_add_u32 v4, 0x2000, v4
    v_mfma_f32_16x16x32_bf16 v[36:39], v[196:199], v[196:199], v[36:39]
    v_fmac_f32 v118, v30, v114
    v_fmac_f32 v119, v31, v114
    v_mfma_f32_16x16x32_bf16 v[24:27], v[48:51], v[200:203], v[24:27]
    v_exp_f32 v120, v116
    v_mfma_f32_16x16x32_bf16 v[36:39], v[200:203], v[200:203], v[36:39]
    global_load_dwordx4 a[144:147], v4, s[28:29] offset:-4096
    v_mfma_f32_16x16x32_bf16 v[24:27], v[48:51], v[204:207], v[24:27]
    v_exp_f32 v121, v117
    v_mfma_f32_16x16x32_bf16 v[36:39], v[204:207], v[204:207], v[36:39]
    v_exp_f32 v122, v118
    v_mfma_f32_16x16x32_bf16 v[24:27], v[48:51], v[208:211], v[24:27]
    v_exp_f32 v123, v119
    v_mfma_f32_16x16x32_bf16 v[36:39], v[208:211], v[208:211], v[36:39]
    v_add_f32 v120, 1.0, v120
    v_add_f32 v121, 1.0, v121
    v_mfma_f32_16x16x32_bf16 v[24:27], v[48:51], v[212:215], v[24:27]
    global_load_dwordx4 a[148:151], v4, s[28:29] offset:-3072
    v_add_f32 v122, 1.0, v122
    v_mfma_f32_16x16x32_bf16 v[36:39], v[212:215], v[212:215], v[36:39]
    v_add_f32 v123, 1.0, v123
    v_mfma_f32_16x16x32_bf16 v[24:27], v[48:51], v[216:219], v[24:27]
    v_rcp_f32 v120, v120
    v_mfma_f32_16x16x32_bf16 v[36:39], v[216:219], v[216:219], v[36:39]
    v_rcp_f32 v121, v121
    v_mfma_f32_16x16x32_bf16 v[24:27], v[48:51], v[220:223], v[24:27]
    global_load_dwordx4 a[152:155], v4, s[28:29] offset:-2048
    v_mfma_f32_16x16x32_bf16 v[36:39], v[220:223], v[220:223], v[36:39]
    v_rcp_f32 v122, v122
    v_mfma_f32_16x16x32_bf16 v[24:27], v[48:51], v[224:227], v[24:27]
    v_rcp_f32 v123, v123
    v_mfma_f32_16x16x32_bf16 v[36:39], v[224:227], v[224:227], v[36:39]
    v_mul_f32 v120, v120, v116
    v_mul_f32 v121, v121, v117
    v_mfma_f32_16x16x32_bf16 v[24:27], v[48:51], v[228:231], v[24:27]
    global_load_dwordx4 a[156:159], v4, s[28:29] offset:-1024
    v_mul_f32 v122, v122, v118
    v_mfma_f32_16x16x32_bf16 v[36:39], v[228:231], v[228:231], v[36:39]
    s_waitcnt lgkmcnt(10)
    v_mul_f32 v123, v123, v119
    v_cvt_pk_bf16_f32 v132, v120, v121
    v_mfma_f32_16x16x32_bf16 v[24:27], v[48:51], v[232:235], v[24:27]
    v_cvt_pk_bf16_f32 v133, v122, v123
    v_mul_f32 v116, v44, v115
    v_mfma_f32_16x16x32_bf16 v[36:39], v[232:235], v[232:235], v[36:39]
    s_waitcnt lgkmcnt(8)
    v_mul_f32 v117, v45, v115
    v_mul_f32 v118, v46, v115
    v_mfma_f32_16x16x32_bf16 v[24:27], v[48:51], v[236:239], v[24:27]
    global_load_dwordx4 a[160:163], v4, s[28:29] offset:0
    v_mul_f32 v119, v47, v115
    v_mfma_f32_16x16x32_bf16 v[36:39], v[236:239], v[236:239], v[36:39]
    s_waitcnt lgkmcnt(6)
    v_fmac_f32 v116, v32, v114
    v_fmac_f32 v117, v33, v114
    v_mfma_f32_16x16x32_bf16 v[24:27], v[48:51], v[240:243], v[24:27]
    s_waitcnt vmcnt(22)
    v_max3_u32 v100, v84, v85, v86
    v_max3_u32 v100, v100, v87, v88
    v_max3_u32 v100, v100, v89, v90
    v_max3_u32 v100, v100, v91, v92
    v_max3_u32 v100, v100, v93, v94
    v_max3_u32 v100, v100, v95, v96
    v_max3_u32 v100, v100, v97, v98
    v_max_u32 v100, v100, v99
    v_cmp_eq_u32 vcc, -1, v100
    v_mfma_f32_16x16x32_bf16 v[36:39], v[240:243], v[240:243], v[36:39]
    s_waitcnt lgkmcnt(4)
    s_cbranch_vccnz L_rh3b
L_bh3b:
    ds_write_b128 v12, v[84:87] offset:49152
    ds_write_b128 v12, v[88:91] offset:50176
    ds_write_b128 v12, v[92:95] offset:51200
    ds_write_b128 v12, v[96:99] offset:52224
    global_load_dwordx4 a[164:167], v4, s[28:29] offset:1024
    global_load_dwordx4 a[168:171], v4, s[28:29] offset:2048
    v_mfma_f32_16x16x32_bf16 v[24:27], v[48:51], v[244:247], v[24:27]
    v_fmac_f32 v118, v34, v114
    v_fmac_f32 v119, v35, v114
    v_mfma_f32_16x16x32_bf16 v[36:39], v[244:247], v[244:247], v[36:39]
    s_waitcnt lgkmcnt(6)
    global_load_dwordx4 a[172:175], v4, s[28:29] offset:3072
    v_add_u32 v4, 0x2000, v4
    v_mfma_f32_16x16x32_bf16 v[24:27], v[48:51], v[248:251], v[24:27]
    v_exp_f32 v120, v116
    v_mfma_f32_16x16x32_bf16 v[36:39], v[248:251], v[248:251], v[36:39]
    s_waitcnt lgkmcnt(4)
    v_exp_f32 v121, v117
    v_mfma_f32_16x16x32_bf16 v[24:27], v[48:51], v[252:255], v[24:27]
    v_exp_f32 v122, v118
    v_mfma_f32_16x16x32_bf16 v[36:39], v[252:255], v[252:255], v[36:39]
    global_load_dwordx4 a[176:179], v4, s[28:29] offset:-4096
    v_mfma_f32_16x16x32_bf16 v[16:19], a[0:3], v[192:195], 0
    v_exp_f32 v123, v119
    v_mfma_f32_16x16x32_bf16 v[20:23], a[4:7], v[192:195], 0
    v_add_f32 v120, 1.0, v120
    v_add_f32 v121, 1.0, v121
    v_mfma_f32_16x16x32_bf16 v[16:19], a[8:11], v[196:199], v[16:19]
    v_add_f32 v122, 1.0, v122
    v_add_f32 v123, 1.0, v123
    v_mfma_f32_16x16x32_bf16 v[20:23], a[12:15], v[196:199], v[20:23]
    v_cndmask_b32 v140, v36, v37, s[12:13]
    v_mul_f32 v141, 0xbb000000, v24
    v_cndmask_b32 v140, v140, v38, s[14:15]
    v_mul_f32 v142, v141, v141
    v_cndmask_b32 v140, v140, v39, s[16:17]
    v_fma_f32 v140, v140, s18, -v142
    v_max_f32 v140, 0, v140
    v_add_f32 v140, 0x3727c5ac, v140
    v_rsq_f32 v140, v140
    v_mfma_f32_16x16x32_bf16 v[16:19], a[16:19], v[200:203], v[16:19]
    global_load_dwordx4 a[180:183], v4, s[28:29] offset:-3072
    v_mul_f32 v140, 0xbfb8aa3b, v140
    v_mul_f32 v141, v141, v140
    v_mfma_f32_16x16x32_bf16 v[20:23], a[20:23], v[200:203], v[20:23]
    ds_write_b64 v14, v[140:141] offset:256
    global_load_dwordx4 a[184:187], v4, s[28:29] offset:-2048
    v_mfma_f32_16x16x32_bf16 v[16:19], a[24:27], v[204:207], v[16:19]
    v_rcp_f32 v120, v120
    v_mfma_f32_16x16x32_bf16 v[20:23], a[28:31], v[204:207], v[20:23]
    v_rcp_f32 v121, v121
    v_mfma_f32_16x16x32_bf16 v[16:19], a[32:35], v[208:211], v[16:19]
    v_rcp_f32 v122, v122
    v_mfma_f32_16x16x32_bf16 v[20:23], a[36:39], v[208:211], v[20:23]
    global_load_dwordx4 a[188:191], v4, s[28:29] offset:-1024
    v_mfma_f32_16x16x32_bf16 v[16:19], a[40:43], v[212:215], v[16:19]
    v_rcp_f32 v123, v123
    v_mfma_f32_16x16x32_bf16 v[20:23], a[44:47], v[212:215], v[20:23]
    v_mul_f32 v120, v120, v116
    v_mul_f32 v121, v121, v117
    v_mfma_f32_16x16x32_bf16 v[16:19], a[48:51], v[216:219], v[16:19]
    v_mul_f32 v122, v122, v118
    v_mul_f32 v123, v123, v119
    v_mfma_f32_16x16x32_bf16 v[20:23], a[52:55], v[216:219], v[20:23]
    global_load_dwordx4 a[192:195], v4, s[28:29] offset:0
    v_cvt_pk_bf16_f32 v134, v120, v121
    v_mfma_f32_16x16x32_bf16 v[16:19], a[56:59], v[220:223], v[16:19]
    v_cvt_pk_bf16_f32 v135, v122, v123
    v_mfma_f32_16x16x32_bf16 v[20:23], a[60:63], v[220:223], v[20:23]
    v_mfma_f32_16x16x32_bf16 v[16:19], a[64:67], v[224:227], v[16:19]
    s_waitcnt lgkmcnt(0)
    s_barrier
    ds_read_b64_tr_b16 v[192:193], v128 offset:49152
    ds_read_b64_tr_b16 v[194:195], v128 offset:49664
    buffer_store_dwordx4 v[132:135], v3, s[48:51], s53 offen sc1
    v_mfma_f32_16x16x32_bf16 v[20:23], a[68:71], v[224:227], v[20:23]
    ds_read_b64_tr_b16 v[196:197], v128 offset:50176
    ds_read_b64_tr_b16 v[198:199], v128 offset:50688
    ds_read_b64 v[112:113], v13 offset:256
    v_mfma_f32_16x16x32_bf16 v[16:19], a[72:75], v[228:231], v[16:19]
    ds_read_b64_tr_b16 v[200:201], v128 offset:51200
    ds_read_b64_tr_b16 v[202:203], v128 offset:51712
    s_add_u32 s53, s53, 180224
    v_mfma_f32_16x16x32_bf16 v[20:23], a[76:79], v[228:231], v[20:23]
    ds_read_b64_tr_b16 v[204:205], v128 offset:52224
    ds_read_b64_tr_b16 v[206:207], v128 offset:52736
    global_load_dwordx4 a[196:199], v4, s[28:29] offset:1024
    v_mfma_f32_16x16x32_bf16 v[16:19], v[144:147], v[232:235], v[16:19]
    ds_read_b64_tr_b16 v[208:209], v129 offset:49152
    ds_read_b64_tr_b16 v[210:211], v129 offset:49664
    v_mfma_f32_16x16x32_bf16 v[20:23], v[148:151], v[232:235], v[20:23]
    ds_read_b64_tr_b16 v[212:213], v129 offset:50176
    v_mfma_f32_16x16x32_bf16 v[16:19], v[152:155], v[236:239], v[16:19]
    v_mfma_f32_16x16x32_bf16 v[20:23], v[156:159], v[236:239], v[20:23]
    ds_read_b64_tr_b16 v[214:215], v129 offset:50688
    ds_read_b64_tr_b16 v[216:217], v129 offset:51200
    global_load_dwordx4 a[200:203], v4, s[28:29] offset:2048
    v_mfma_f32_16x16x32_bf16 v[16:19], v[160:163], v[240:243], v[16:19]
    s_waitcnt lgkmcnt(7)
    ds_read_b64_tr_b16 v[218:219], v129 offset:51712
    ds_read_b64_tr_b16 v[220:221], v129 offset:52224
    v_mfma_f32_16x16x32_bf16 v[20:23], v[164:167], v[240:243], v[20:23]
    ds_read_b64_tr_b16 v[222:223], v129 offset:52736
    ds_read_b64_tr_b16 v[224:225], v130 offset:49152
    v_mfma_f32_16x16x32_bf16 v[16:19], v[168:171], v[244:247], v[16:19]
    ds_read_b64_tr_b16 v[226:227], v130 offset:49664
    ds_read_b64_tr_b16 v[228:229], v130 offset:50176
    v_mfma_f32_16x16x32_bf16 v[20:23], v[172:175], v[244:247], v[20:23]
    ds_read_b64_tr_b16 v[230:231], v130 offset:50688
    ds_read_b64_tr_b16 v[232:233], v130 offset:51200
    global_load_dwordx4 a[204:207], v4, s[28:29] offset:3072
    v_add_u32 v4, 0x2000, v4
    v_mfma_f32_16x16x32_bf16 v[16:19], v[176:179], v[248:251], v[16:19]
    v_mfma_f32_16x16x32_bf16 v[20:23], v[180:183], v[248:251], v[20:23]
    s_waitcnt lgkmcnt(8)
    ds_read_b64_tr_b16 v[234:235], v130 offset:51712
    ds_read_b64_tr_b16 v[236:237], v130 offset:52224
    v_mfma_f32_16x16x32_bf16 v[16:19], v[184:187], v[252:255], v[16:19]
    ds_read_b64_tr_b16 v[238:239], v130 offset:52736
    ds_read_b64_tr_b16 v[240:241], v131 offset:49152
    global_load_dwordx4 a[208:211], v4, s[28:29] offset:-4096
    v_mfma_f32_16x16x32_bf16 v[20:23], v[188:191], v[252:255], v[20:23]
    ds_read_b64_tr_b16 v[242:243], v131 offset:49664
    ds_read_b64_tr_b16 v[244:245], v131 offset:50176
    v_mul_f32 v116, v40, v113
    v_mul_f32 v117, v41, v113
    v_mfma_f32_16x16x32_bf16 v[24:27], v[48:51], v[192:195], 0
    s_waitcnt lgkmcnt(6)
    ds_read_b64_tr_b16 v[246:247], v131 offset:50688
    ds_read_b64_tr_b16 v[248:249], v131 offset:51200
    v_mul_f32 v118, v42, v113
    v_mfma_f32_16x16x32_bf16 v[36:39], v[192:195], v[192:195], 0
    ds_read_b64_tr_b16 v[250:251], v131 offset:51712
    ds_read_b64_tr_b16 v[252:253], v131 offset:52224
    global_load_dwordx4 a[212:215], v4, s[28:29] offset:-3072
    v_mul_f32 v119, v43, v113
    v_fmac_f32 v116, v16, v112
    v_mfma_f32_16x16x32_bf16 v[24:27], v[48:51], v[196:199], v[24:27]
    ds_read_b64_tr_b16 v[254:255], v131 offset:52736
    v_fmac_f32 v117, v17, v112
    v_mfma_f32_16x16x32_bf16 v[36:39], v[196:199], v[196:199], v[36:39]
    v_fmac_f32 v118, v18, v112
    v_fmac_f32 v119, v19, v112
    v_mfma_f32_16x16x32_bf16 v[24:27], v[48:51], v[200:203], v[24:27]
    v_exp_f32 v120, v116
    v_mfma_f32_16x16x32_bf16 v[36:39], v[200:203], v[200:203], v[36:39]
    global_load_dwordx4 a[216:219], v4, s[28:29] offset:-2048
    v_mfma_f32_16x16x32_bf16 v[24:27], v[48:51], v[204:207], v[24:27]
    v_exp_f32 v121, v117
    v_mfma_f32_16x16x32_bf16 v[36:39], v[204:207], v[204:207], v[36:39]
    v_exp_f32 v122, v118
    v_mfma_f32_16x16x32_bf16 v[24:27], v[48:51], v[208:211], v[24:27]
    v_exp_f32 v123, v119
    v_mfma_f32_16x16x32_bf16 v[36:39], v[208:211], v[208:211], v[36:39]
    global_load_dwordx4 a[220:223], v4, s[28:29] offset:-1024
    v_add_f32 v120, 1.0, v120
    v_mfma_f32_16x16x32_bf16 v[24:27], v[48:51], v[212:215], v[24:27]
    v_add_f32 v121, 1.0, v121
    v_add_f32 v122, 1.0, v122
    v_mfma_f32_16x16x32_bf16 v[36:39], v[212:215], v[212:215], v[36:39]
    v_add_f32 v123, 1.0, v123
    v_mfma_f32_16x16x32_bf16 v[24:27], v[48:51], v[216:219], v[24:27]
    v_rcp_f32 v120, v120
    v_mfma_f32_16x16x32_bf16 v[36:39], v[216:219], v[216:219], v[36:39]
    v_rcp_f32 v121, v121
    v_mfma_f32_16x16x32_bf16 v[24:27], v[48:51], v[220:223], v[24:27]
    global_load_dwordx4 a[224:227], v4, s[28:29] offset:0
    v_mfma_f32_16x16x32_bf16 v[36:39], v[220:223], v[220:223], v[36:39]
    v_rcp_f32 v122, v122
    v_mfma_f32_16x16x32_bf16 v[24:27], v[48:51], v[224:227], v[24:27]
    v_rcp_f32 v123, v123
    v_mfma_f32_16x16x32_bf16 v[36:39], v[224:227], v[224:227], v[36:39]
    v_mul_f32 v120, v120, v116
    v_mul_f32 v121, v121, v117
    v_mfma_f32_16x16x32_bf16 v[24:27], v[48:51], v[228:231], v[24:27]
    global_load_dwordx4 a[228:231], v4, s[28:29] offset:1024
    v_mul_f32 v122, v122, v118
    v_mfma_f32_16x16x32_bf16 v[36:39], v[228:231], v[228:231], v[36:39]
    s_waitcnt lgkmcnt(10)
    v_mul_f32 v123, v123, v119
    v_cvt_pk_bf16_f32 v132, v120, v121
    v_mfma_f32_16x16x32_bf16 v[24:27], v[48:51], v[232:235], v[24:27]
    v_cvt_pk_bf16_f32 v133, v122, v123
    v_mul_f32 v116, v44, v113
    v_mfma_f32_16x16x32_bf16 v[36:39], v[232:235], v[232:235], v[36:39]
    s_waitcnt lgkmcnt(8)
    v_mul_f32 v117, v45, v113
    v_mul_f32 v118, v46, v113
    v_mfma_f32_16x16x32_bf16 v[24:27], v[48:51], v[236:239], v[24:27]
    global_load_dwordx4 a[232:235], v4, s[28:29] offset:2048
    v_mul_f32 v119, v47, v113
    v_mfma_f32_16x16x32_bf16 v[36:39], v[236:239], v[236:239], v[36:39]
    s_waitcnt lgkmcnt(6)
    v_fmac_f32 v116, v20, v112
    v_fmac_f32 v117, v21, v112
    v_mfma_f32_16x16x32_bf16 v[24:27], v[48:51], v[240:243], v[24:27]
    v_fmac_f32 v118, v22, v112
    v_fmac_f32 v119, v23, v112
    v_mfma_f32_16x16x32_bf16 v[36:39], v[240:243], v[240:243], v[36:39]
    s_waitcnt lgkmcnt(4)
    v_exp_f32 v120, v116
    v_mfma_f32_16x16x32_bf16 v[24:27], v[48:51], v[244:247], v[24:27]
    global_load_dwordx4 a[236:239], v4, s[28:29] offset:3072
    v_add_u32 v4, 0x2000, v4
    v_mfma_f32_16x16x32_bf16 v[36:39], v[244:247], v[244:247], v[36:39]
    s_waitcnt lgkmcnt(2)
    v_exp_f32 v121, v117
    v_mfma_f32_16x16x32_bf16 v[24:27], v[48:51], v[248:251], v[24:27]
    v_exp_f32 v122, v118
    v_mfma_f32_16x16x32_bf16 v[36:39], v[248:251], v[248:251], v[36:39]
    s_waitcnt lgkmcnt(0)
    v_exp_f32 v123, v119
    v_mfma_f32_16x16x32_bf16 v[24:27], v[48:51], v[252:255], v[24:27]
    global_load_dwordx4 a[240:243], v4, s[28:29] offset:-4096
    v_add_f32 v120, 1.0, v120
    v_mfma_f32_16x16x32_bf16 v[36:39], v[252:255], v[252:255], v[36:39]
    v_add_f32 v121, 1.0, v121
    v_add_f32 v122, 1.0, v122
    v_mfma_f32_16x16x32_bf16 v[28:31], a[0:3], v[192:195], 0
    v_add_f32 v123, 1.0, v123
    v_mfma_f32_16x16x32_bf16 v[32:35], a[4:7], v[192:195], 0
    v_rcp_f32 v120, v120
    v_mfma_f32_16x16x32_bf16 v[28:31], a[8:11], v[196:199], v[28:31]
    global_load_dwordx4 a[244:247], v4, s[28:29] offset:-3072
    v_mfma_f32_16x16x32_bf16 v[32:35], a[12:15], v[196:199], v[32:35]
    v_cndmask_b32 v140, v36, v37, s[12:13]
    v_mul_f32 v141, 0xbb000000, v24
    v_cndmask_b32 v140, v140, v38, s[14:15]
    v_mfma_f32_16x16x32_bf16 v[28:31], a[16:19], v[200:203], v[28:31]
    v_mul_f32 v142, v141, v141
    v_cndmask_b32 v140, v140, v39, s[16:17]
    v_fma_f32 v140, v140, s18, -v142
    v_mfma_f32_16x16x32_bf16 v[32:35], a[20:23], v[200:203], v[32:35]
    v_max_f32 v140, 0, v140
    v_add_f32 v140, 0x3727c5ac, v140
    v_rsq_f32 v140, v140
    v_mfma_f32_16x16x32_bf16 v[28:31], a[24:27], v[204:207], v[28:31]
    global_load_dwordx4 a[248:251], v4, s[28:29] offset:-2048
    v_mul_f32 v140, 0xbfb8aa3b, v140
    v_mul_f32 v141, v141, v140
    v_mfma_f32_16x16x32_bf16 v[32:35], a[28:31], v[204:207], v[32:35]
    ds_write_b64 v14, v[140:141] offset:384
    v_rcp_f32 v121, v121
    v_mfma_f32_16x16x32_bf16 v[28:31], a[32:35], v[208:211], v[28:31]
    global_load_dwordx4 a[252:255], v4, s[28:29] offset:-1024
    v_mfma_f32_16x16x32_bf16 v[32:35], a[36:39], v[208:211], v[32:35]
    v_rcp_f32 v122, v122
    v_mfma_f32_16x16x32_bf16 v[28:31], a[40:43], v[212:215], v[28:31]
    v_rcp_f32 v123, v123
    v_mfma_f32_16x16x32_bf16 v[32:35], a[44:47], v[212:215], v[32:35]
    v_mul_f32 v120, v120, v116
    v_mul_f32 v121, v121, v117
    v_mfma_f32_16x16x32_bf16 v[28:31], a[48:51], v[216:219], v[28:31]
    v_mul_f32 v122, v122, v118
    v_mul_f32 v123, v123, v119
    v_mfma_f32_16x16x32_bf16 v[32:35], a[52:55], v[216:219], v[32:35]
    global_load_dwordx4 v[68:71], v5, s[28:29] offset:-4096 sc1
    v_cvt_pk_bf16_f32 v134, v120, v121
    v_mfma_f32_16x16x32_bf16 v[28:31], a[56:59], v[220:223], v[28:31]
    v_cvt_pk_bf16_f32 v135, v122, v123
    v_mfma_f32_16x16x32_bf16 v[32:35], a[60:63], v[220:223], v[32:35]
    v_mfma_f32_16x16x32_bf16 v[28:31], a[64:67], v[224:227], v[28:31]
    s_waitcnt lgkmcnt(0)
    s_barrier
    ds_read_b64 v[114:115], v13 offset:384
    buffer_store_dwordx4 v[132:135], v3, s[48:51], s53 offen sc1
    v_mfma_f32_16x16x32_bf16 v[32:35], a[68:71], v[224:227], v[32:35]
    s_add_u32 s53, s53, 180224
    v_mfma_f32_16x16x32_bf16 v[28:31], a[72:75], v[228:231], v[28:31]
    v_mfma_f32_16x16x32_bf16 v[32:35], a[76:79], v[228:231], v[32:35]
    v_mfma_f32_16x16x32_bf16 v[28:31], v[144:147], v[232:235], v[28:31]
    global_load_dwordx4 v[72:75], v5, s[28:29] offset:-3072 sc1
    v_mfma_f32_16x16x32_bf16 v[32:35], v[148:151], v[232:235], v[32:35]
    v_mfma_f32_16x16x32_bf16 v[28:31], v[152:155], v[236:239], v[28:31]
    v_mfma_f32_16x16x32_bf16 v[32:35], v[156:159], v[236:239], v[32:35]
    v_mfma_f32_16x16x32_bf16 v[28:31], v[160:163], v[240:243], v[28:31]
    global_load_dwordx4 v[76:79], v5, s[28:29] offset:-2048 sc1
    v_mfma_f32_16x16x32_bf16 v[32:35], v[164:167], v[240:243], v[32:35]
    v_mfma_f32_16x16x32_bf16 v[28:31], v[168:171], v[244:247], v[28:31]
    v_mfma_f32_16x16x32_bf16 v[32:35], v[172:175], v[244:247], v[32:35]
    v_mfma_f32_16x16x32_bf16 v[28:31], v[176:179], v[248:251], v[28:31]
    global_load_dwordx4 v[80:83], v5, s[28:29] offset:-1024 sc1
    v_mfma_f32_16x16x32_bf16 v[32:35], v[180:183], v[248:251], v[32:35]
    v_mfma_f32_16x16x32_bf16 v[28:31], v[184:187], v[252:255], v[28:31]
    v_mfma_f32_16x16x32_bf16 v[32:35], v[188:191], v[252:255], v[32:35]
    s_waitcnt lgkmcnt(0)
    v_pk_mul_f32 v[116:117], v[40:41], v[114:115] op_sel:[0,1] op_sel_hi:[1,1]
    global_load_dwordx4 v[84:87], v5, s[28:29] offset:0 sc1
    v_pk_mul_f32 v[118:119], v[42:43], v[114:115] op_sel:[0,1] op_sel_hi:[1,1]
    s_nop 2
    v_pk_fma_f32 v[116:117], v[28:29], v[114:115], v[116:117] op_sel_hi:[1,0,1]
    v_pk_fma_f32 v[118:119], v[30:31], v[114:115], v[118:119] op_sel_hi:[1,0,1]
    v_exp_f32 v120, v116
    v_exp_f32 v121, v117
    v_exp_f32 v122, v118
    v_exp_f32 v123, v119
    v_pk_add_f32 v[120:121], v[120:121], 1.0 op_sel_hi:[1,0]
    global_load_dwordx4 v[88:91], v5, s[28:29] offset:1024 sc1
    v_pk_add_f32 v[122:123], v[122:123], 1.0 op_sel_hi:[1,0]
    v_rcp_f32 v120, v120
    v_rcp_f32 v121, v121
    v_rcp_f32 v122, v122
    v_rcp_f32 v123, v123
    v_pk_mul_f32 v[120:121], v[120:121], v[116:117]
    v_pk_mul_f32 v[122:123], v[122:123], v[118:119]
    v_cvt_pk_bf16_f32 v132, v120, v121
    global_load_dwordx4 v[92:95], v5, s[28:29] offset:2048 sc1
    v_cvt_pk_bf16_f32 v133, v122, v123
    v_pk_mul_f32 v[116:117], v[44:45], v[114:115] op_sel:[0,1] op_sel_hi:[1,1]
    v_pk_mul_f32 v[118:119], v[46:47], v[114:115] op_sel:[0,1] op_sel_hi:[1,1]
    v_pk_fma_f32 v[116:117], v[32:33], v[114:115], v[116:117] op_sel_hi:[1,0,1]
    v_pk_fma_f32 v[118:119], v[34:35], v[114:115], v[118:119] op_sel_hi:[1,0,1]
    v_exp_f32 v120, v116
    v_exp_f32 v121, v117
    v_exp_f32 v122, v118
    v_exp_f32 v123, v119
    global_load_dwordx4 v[96:99], v5, s[28:29] offset:3072 sc1
    v_add_u32 v5, 0x1000, v5
    v_pk_add_f32 v[120:121], v[120:121], 1.0 op_sel_hi:[1,0]
    v_pk_add_f32 v[122:123], v[122:123], 1.0 op_sel_hi:[1,0]
    v_rcp_f32 v120, v120
    v_rcp_f32 v121, v121
    v_rcp_f32 v122, v122
    v_rcp_f32 v123, v123
    v_pk_mul_f32 v[120:121], v[120:121], v[116:117]
    global_load_dwordx4 v[100:103], v5, s[28:29] offset:0 sc1
    v_pk_mul_f32 v[122:123], v[122:123], v[118:119]
    v_cvt_pk_bf16_f32 v134, v120, v121
    v_cvt_pk_bf16_f32 v135, v122, v123
    buffer_store_dwordx4 v[132:135], v3, s[48:51], s53 offen sc1
L_g2:
    s_waitcnt vmcnt(10)
    v_mfma_f32_16x16x32_bf16 v[16:19], a[80:83], v[68:71], 0
    v_mfma_f32_16x16x32_bf16 a[44:47], a[84:87], v[68:71], 0
    v_mfma_f32_16x16x32_bf16 a[48:51], a[88:91], v[68:71], 0
    v_mfma_f32_16x16x32_bf16 a[52:55], a[92:95], v[68:71], 0
    s_waitcnt vmcnt(8)
    v_mfma_f32_16x16x32_bf16 v[16:19], a[96:99], v[72:75], v[16:19]
    global_load_dwordx4 v[104:107], v5, s[28:29] offset:1024 sc1
    v_mfma_f32_16x16x32_bf16 a[44:47], a[100:103], v[72:75], a[44:47]
    global_load_dwordx4 v[108:111], v5, s[28:29] offset:2048 sc1
    v_add_u32 v5, 0x2b000, v5
    v_mfma_f32_16x16x32_bf16 a[48:51], a[104:107], v[72:75], a[48:51]
    v_mfma_f32_16x16x32_bf16 a[52:55], a[108:111], v[72:75], a[52:55]
    s_waitcnt vmcnt(9)
    v_mfma_f32_16x16x32_bf16 v[16:19], a[112:115], v[76:79], v[16:19]
    v_mfma_f32_16x16x32_bf16 a[44:47], a[116:119], v[76:79], a[44:47]
    global_load_dwordx4 a[0:3], v5, s[28:29] offset:-4096 sc1
    v_mfma_f32_16x16x32_bf16 a[48:51], a[120:123], v[76:79], a[48:51]
    v_mfma_f32_16x16x32_bf16 a[52:55], a[124:127], v[76:79], a[52:55]
    s_waitcnt vmcnt(9)
    v_mfma_f32_16x16x32_bf16 v[16:19], a[128:131], v[80:83], v[16:19]
    v_mfma_f32_16x16x32_bf16 a[44:47], a[132:135], v[80:83], a[44:47]
    global_load_dwordx4 a[4:7], v5, s[28:29] offset:-3072 sc1
    v_mfma_f32_16x16x32_bf16 a[48:51], a[136:139], v[80:83], a[48:51]
    v_mfma_f32_16x16x32_bf16 a[52:55], a[140:143], v[80:83], a[52:55]
    s_waitcnt vmcnt(9)
    v_mfma_f32_16x16x32_bf16 v[16:19], a[144:147], v[84:87], v[16:19]
    v_mfma_f32_16x16x32_bf16 a[44:47], a[148:151], v[84:87], a[44:47]
    global_load_dwordx4 a[8:11], v5, s[28:29] offset:-2048 sc1
    v_mfma_f32_16x16x32_bf16 a[48:51], a[152:155], v[84:87], a[48:51]
    v_mfma_f32_16x16x32_bf16 a[52:55], a[156:159], v[84:87], a[52:55]
    s_waitcnt vmcnt(8)
    v_mfma_f32_16x16x32_bf16 v[16:19], a[160:163], v[88:91], v[16:19]
    v_mfma_f32_16x16x32_bf16 a[44:47], a[164:167], v[88:91], a[44:47]
    global_load_dwordx4 a[12:15], v5, s[28:29] offset:-1024 sc1
    v_mfma_f32_16x16x32_bf16 a[48:51], a[168:171], v[88:91], a[48:51]
    v_mfma_f32_16x16x32_bf16 a[52:55], a[172:175], v[88:91], a[52:55]
    s_waitcnt vmcnt(8)
    v_mfma_f32_16x16x32_bf16 v[16:19], a[176:179], v[92:95], v[16:19]
    v_mfma_f32_16x16x32_bf16 a[44:47], a[180:183], v[92:95], a[44:47]
    global_load_dwordx4 a[16:19], v5, s[28:29] offset:0 sc1
    v_mfma_f32_16x16x32_bf16 a[48:51], a[184:187], v[92:95], a[48:51]
    v_mfma_f32_16x16x32_bf16 a[52:55], a[188:191], v[92:95], a[52:55]
    s_waitcnt vmcnt(8)
    v_mfma_f32_16x16x32_bf16 v[16:19], a[192:195], v[96:99], v[16:19]
    v_mfma_f32_16x16x32_bf16 a[44:47], a[196:199], v[96:99], a[44:47]
    global_load_dwordx4 a[20:23], v5, s[28:29] offset:1024 sc1
    v_mfma_f32_16x16x32_bf16 a[48:51], a[200:203], v[96:99], a[48:51]
    v_mfma_f32_16x16x32_bf16 a[52:55], a[204:207], v[96:99], a[52:55]
    s_waitcnt vmcnt(8)
    ds_read_b64_tr_b16 v[36:37], v10 offset:0
    v_mfma_f32_16x16x32_bf16 v[16:19], a[208:211], v[100:103], v[16:19]
    v_mfma_f32_16x16x32_bf16 a[44:47], a[212:215], v[100:103], a[44:47]
    global_load_dwordx4 a[24:27], v5, s[28:29] offset:2048 sc1
    v_mfma_f32_16x16x32_bf16 a[48:51], a[216:219], v[100:103], a[48:51]
    v_mfma_f32_16x16x32_bf16 a[52:55], a[220:223], v[100:103], a[52:55]
    s_waitcnt vmcnt(8)
    v_mfma_f32_16x16x32_bf16 v[16:19], a[224:227], v[104:107], v[16:19]
    s_waitcnt lgkmcnt(0)
    global_load_dwordx4 a[28:31], v5, s[28:29] offset:3072 sc1
    v_lshlrev_b32 v40, 16, v36
    v_and_b32 v41, 0xffff0000, v36
    v_lshlrev_b32 v42, 16, v37
    v_and_b32 v43, 0xffff0000, v37
    v_add_u32 v5, 0x1000, v5
    v_mfma_f32_16x16x32_bf16 a[44:47], a[228:231], v[104:107], a[44:47]
    global_load_dwordx4 a[32:35], v5, s[28:29] offset:0 sc1
    global_load_dwordx4 a[36:39], v5, s[28:29] offset:1024 sc1
    global_load_dwordx4 a[40:43], v5, s[28:29] offset:2048 sc1
    v_add_u32 v5, 0x2b000, v5
    v_mfma_f32_16x16x32_bf16 a[48:51], a[232:235], v[104:107], a[48:51]
    v_mfma_f32_16x16x32_bf16 a[52:55], a[236:239], v[104:107], a[52:55]
    s_waitcnt vmcnt(11)
    global_load_dwordx4 v[144:147], v5, s[28:29] offset:-4096 sc1
    v_mfma_f32_16x16x32_bf16 v[16:19], a[240:243], v[108:111], v[16:19]
    v_mfma_f32_16x16x32_bf16 a[44:47], a[244:247], v[108:111], a[44:47]
    v_mfma_f32_16x16x32_bf16 a[48:51], a[248:251], v[108:111], a[48:51]
    v_mfma_f32_16x16x32_bf16 a[52:55], a[252:255], v[108:111], a[52:55]
    s_waitcnt vmcnt(11)
    global_load_dwordx4 v[148:151], v5, s[28:29] offset:-3072 sc1
    v_mfma_f32_16x16x32_bf16 v[20:23], a[80:83], a[0:3], 0
    v_mfma_f32_16x16x32_bf16 a[56:59], a[84:87], a[0:3], 0
    v_mfma_f32_16x16x32_bf16 a[60:63], a[88:91], a[0:3], 0
    v_cmp_u_f32 vcc, v16, v16
    v_mfma_f32_16x16x32_bf16 a[64:67], a[92:95], a[0:3], 0
    s_waitcnt vmcnt(11)
    s_cbranch_vccnz L_rf0
L_bf0:
    ds_write_b128 v6, a[44:47] offset:0
    global_load_dwordx4 v[152:155], v5, s[28:29] offset:-2048 sc1
    v_mfma_f32_16x16x32_bf16 v[20:23], a[96:99], a[4:7], v[20:23]
    ds_write_b128 v6, a[48:51] offset:1024
    v_mfma_f32_16x16x32_bf16 a[56:59], a[100:103], a[4:7], a[56:59]
    ds_write_b128 v6, a[52:55] offset:2048
    global_load_dwordx4 v[156:159], v5, s[28:29] offset:-1024 sc1
    v_mfma_f32_16x16x32_bf16 a[60:63], a[104:107], a[4:7], a[60:63]
    v_mfma_f32_16x16x32_bf16 a[64:67], a[108:111], a[4:7], a[64:67]
    s_waitcnt vmcnt(12)
    v_mfma_f32_16x16x32_bf16 v[20:23], a[112:115], a[8:11], v[20:23]
    s_waitcnt lgkmcnt(0)
    s_barrier
    ds_read_b128 v[24:27], v7 offset:0
    ds_read_b128 v[28:31], v8 offset:0
    global_load_dwordx4 v[160:163], v5, s[28:29] offset:0 sc1
    v_mfma_f32_16x16x32_bf16 a[56:59], a[116:119], a[8:11], a[56:59]
    ds_read_b128 v[32:35], v9 offset:0
    v_mfma_f32_16x16x32_bf16 a[60:63], a[120:123], a[8:11], a[60:63]
    v_mfma_f32_16x16x32_bf16 a[64:67], a[124:127], a[8:11], a[64:67]
    s_waitcnt vmcnt(12)
    v_mfma_f32_16x16x32_bf16 v[20:23], a[128:131], a[12:15], v[20:23]
    global_load_dwordx4 v[164:167], v5, s[28:29] offset:1024 sc1
    v_mfma_f32_16x16x32_bf16 a[56:59], a[132:135], a[12:15], a[56:59]
    v_mfma_f32_16x16x32_bf16 a[60:63], a[136:139], a[12:15], a[60:63]
    v_mfma_f32_16x16x32_bf16 a[64:67], a[140:143], a[12:15], a[64:67]
    s_waitcnt vmcnt(12)
    v_mfma_f32_16x16x32_bf16 v[20:23], a[144:147], a[16:19], v[20:23]
    global_load_dwordx4 v[168:171], v5, s[28:29] offset:2048 sc1
    v_mfma_f32_16x16x32_bf16 a[56:59], a[148:151], a[16:19], a[56:59]
    s_waitcnt lgkmcnt(2)
    v_add_f32 v16, v16, v24
    v_add_f32 v17, v17, v25
    v_mfma_f32_16x16x32_bf16 a[60:63], a[152:155], a[16:19], a[60:63]
    v_add_f32 v18, v18, v26
    v_add_f32 v19, v19, v27
    v_mfma_f32_16x16x32_bf16 a[64:67], a[156:159], a[16:19], a[64:67]
    s_waitcnt vmcnt(12) lgkmcnt(1)
    v_add_f32 v16, v16, v28
    v_add_f32 v17, v17, v29
    v_mfma_f32_16x16x32_bf16 v[20:23], a[160:163], a[20:23], v[20:23]
    global_load_dwordx4 v[172:175], v5, s[28:29] offset:3072 sc1
    v_add_f32 v18, v18, v30
    v_add_u32 v5, 0x1000, v5
    v_mfma_f32_16x16x32_bf16 a[56:59], a[164:167], a[20:23], a[56:59]
    s_waitcnt lgkmcnt(0)
    v_add_f32 v19, v19, v31
    v_add_f32 v16, v16, v32
    v_mfma_f32_16x16x32_bf16 a[60:63], a[168:171], a[20:23], a[60:63]
    v_add_f32 v17, v17, v33
    v_add_f32 v18, v18, v34
    v_mfma_f32_16x16x32_bf16 a[64:67], a[172:175], a[20:23], a[64:67]
    s_waitcnt vmcnt(12)
    v_add_f32 v19, v19, v35
    v_fma_f32 v40, v16, s58, v40
    v_mfma_f32_16x16x32_bf16 v[20:23], a[176:179], a[24:27], v[20:23]
    global_load_dwordx4 v[176:179], v5, s[28:29] offset:0 sc1
    v_fma_f32 v41, v17, s58, v41
    v_mfma_f32_16x16x32_bf16 a[56:59], a[180:183], a[24:27], a[56:59]
    v_fma_f32 v42, v18, s58, v42
    v_fma_f32 v43, v19, s58, v43
    v_mfma_f32_16x16x32_bf16 a[60:63], a[184:187], a[24:27], a[60:63]
    v_cvt_pk_bf16_f32 v44, v40, v41
    v_cvt_pk_bf16_f32 v45, v42, v43
    v_mfma_f32_16x16x32_bf16 a[64:67], a[188:191], a[24:27], a[64:67]
    s_waitcnt vmcnt(12)
    global_store_dwordx2 v15, v[44:45], s[24:25]
    v_mfma_f32_16x16x32_bf16 v[20:23], a[192:195], a[28:31], v[20:23]
    v_add_u32 v15, 0x80000, v15
    v_mfma_f32_16x16x32_bf16 a[56:59], a[196:199], a[28:31], a[56:59]
    v_mfma_f32_16x16x32_bf16 a[60:63], a[200:203], a[28:31], a[60:63]
    global_load_dwordx4 v[180:183], v5, s[28:29] offset:1024 sc1
    v_mfma_f32_16x16x32_bf16 a[64:67], a[204:207], a[28:31], a[64:67]
    s_waitcnt vmcnt(13)
    ds_read_b64_tr_b16 v[36:37], v10 offset:16384
    v_mfma_f32_16x16x32_bf16 v[20:23], a[208:211], a[32:35], v[20:23]
    v_mfma_f32_16x16x32_bf16 a[56:59], a[212:215], a[32:35], a[56:59]
    v_mfma_f32_16x16x32_bf16 a[60:63], a[216:219], a[32:35], a[60:63]
    global_load_dwordx4 v[184:187], v5, s[28:29] offset:2048 sc1
    v_add_u32 v5, 0x2b000, v5
    v_mfma_f32_16x16x32_bf16 a[64:67], a[220:223], a[32:35], a[64:67]
    s_waitcnt vmcnt(13)
    v_mfma_f32_16x16x32_bf16 v[20:23], a[224:227], a[36:39], v[20:23]
    v_mfma_f32_16x16x32_bf16 a[56:59], a[228:231], a[36:39], a[56:59]
    v_mfma_f32_16x16x32_bf16 a[60:63], a[232:235], a[36:39], a[60:63]
    global_load_dwordx4 v[68:71], v5, s[28:29] offset:-4096 sc1
    v_mfma_f32_16x16x32_bf16 a[64:67], a[236:239], a[36:39], a[64:67]
    s_waitcnt vmcnt(13) lgkmcnt(0)
    v_lshlrev_b32 v40, 16, v36
    v_and_b32 v41, 0xffff0000, v36
    v_mfma_f32_16x16x32_bf16 v[20:23], a[240:243], a[40:43], v[20:23]
    v_lshlrev_b32 v42, 16, v37
    v_and_b32 v43, 0xffff0000, v37
    v_mfma_f32_16x16x32_bf16 a[56:59], a[244:247], a[40:43], a[56:59]
    v_mfma_f32_16x16x32_bf16 a[60:63], a[248:251], a[40:43], a[60:63]
    global_load_dwordx4 v[72:75], v5, s[28:29] offset:-3072 sc1
    v_mfma_f32_16x16x32_bf16 a[64:67], a[252:255], a[40:43], a[64:67]
    s_waitcnt vmcnt(13)
    v_mfma_f32_16x16x32_bf16 v[16:19], a[80:83], v[144:147], 0
    v_cmp_u_f32 vcc, v20, v20
    v_mfma_f32_16x16x32_bf16 a[44:47], a[84:87], v[144:147], 0
    s_cbranch_vccnz L_rf1
L_bf1:
    v_mfma_f32_16x16x32_bf16 a[48:51], a[88:91], v[144:147], 0
    global_load_dwordx4 v[76:79], v5, s[28:29] offset:-2048 sc1
    v_mfma_f32_16x16x32_bf16 a[52:55], a[92:95], v[144:147], 0
    s_waitcnt vmcnt(13)
    ds_write_b128 v6, a[56:59] offset:12288
    v_mfma_f32_16x16x32_bf16 v[16:19], a[96:99], v[148:151], v[16:19]
    ds_write_b128 v6, a[60:63] offset:13312
    global_load_dwordx4 v[80:83], v5, s[28:29] offset:-1024 sc1
    v_mfma_f32_16x16x32_bf16 a[44:47], a[100:103], v[148:151], a[44:47]
    ds_write_b128 v6, a[64:67] offset:14336
    v_mfma_f32_16x16x32_bf16 a[48:51], a[104:107], v[148:151], a[48:51]
    v_mfma_f32_16x16x32_bf16 a[52:55], a[108:111], v[148:151], a[52:55]
    s_waitcnt vmcnt(13)
    global_load_dwordx4 v[84:87], v5, s[28:29] offset:0 sc1
    v_mfma_f32_16x16x32_bf16 v[16:19], a[112:115], v[152:155], v[16:19]
    v_mfma_f32_16x16x32_bf16 a[44:47], a[116:119], v[152:155], a[44:47]
    s_waitcnt lgkmcnt(0)
    s_barrier
    ds_read_b128 v[24:27], v7 offset:12288
    ds_read_b128 v[28:31], v8 offset:12288
    v_mfma_f32_16x16x32_bf16 a[48:51], a[120:123], v[152:155], a[48:51]
    ds_read_b128 v[32:35], v9 offset:12288
    v_mfma_f32_16x16x32_bf16 a[52:55], a[124:127], v[152:155], a[52:55]
    s_waitcnt vmcnt(13)
    global_load_dwordx4 v[88:91], v5, s[28:29] offset:1024 sc1
    v_mfma_f32_16x16x32_bf16 v[16:19], a[128:131], v[156:159], v[16:19]
    v_mfma_f32_16x16x32_bf16 a[44:47], a[132:135], v[156:159], a[44:47]
    v_mfma_f32_16x16x32_bf16 a[48:51], a[136:139], v[156:159], a[48:51]
    v_mfma_f32_16x16x32_bf16 a[52:55], a[140:143], v[156:159], a[52:55]
    s_waitcnt vmcnt(13)
    global_load_dwordx4 v[92:95], v5, s[28:29] offset:2048 sc1
    v_mfma_f32_16x16x32_bf16 v[16:19], a[144:147], v[160:163], v[16:19]
    v_mfma_f32_16x16x32_bf16 a[44:47], a[148:151], v[160:163], a[44:47]
    s_waitcnt lgkmcnt(2)
    v_add_f32 v20, v20, v24
    v_add_f32 v21, v21, v25
    v_mfma_f32_16x16x32_bf16 a[48:51], a[152:155], v[160:163], a[48:51]
    v_add_f32 v22, v22, v26
    v_add_f32 v23, v23, v27
    v_mfma_f32_16x16x32_bf16 a[52:55], a[156:159], v[160:163], a[52:55]
    s_waitcnt vmcnt(13) lgkmcnt(1)
    v_add_f32 v20, v20, v28
    v_add_f32 v21, v21, v29
    v_mfma_f32_16x16x32_bf16 v[16:19], a[160:163], v[164:167], v[16:19]
    global_load_dwordx4 v[96:99], v5, s[28:29] offset:3072 sc1
    v_add_f32 v22, v22, v30
    v_add_u32 v5, 0x1000, v5
    v_mfma_f32_16x16x32_bf16 a[44:47], a[164:167], v[164:167], a[44:47]
    s_waitcnt lgkmcnt(0)
    v_add_f32 v23, v23, v31
    v_add_f32 v20, v20, v32
    v_mfma_f32_16x16x32_bf16 a[48:51], a[168:171], v[164:167], a[48:51]
    v_add_f32 v21, v21, v33
    v_add_f32 v22, v22, v34
    v_mfma_f32_16x16x32_bf16 a[52:55], a[172:175], v[164:167], a[52:55]
    s_waitcnt vmcnt(13)
    global_load_dwordx4 v[100:103], v5, s[28:29] offset:0 sc1
    v_add_f32 v23, v23, v35
    v_mfma_f32_16x16x32_bf16 v[16:19], a[176:179], v[168:171], v[16:19]
    v_fma_f32 v40, v20, s58, v40
    v_fma_f32 v41, v21, s58, v41
    v_mfma_f32_16x16x32_bf16 a[44:47], a[180:183], v[168:171], a[44:47]
    v_fma_f32 v42, v22, s58, v42
    v_fma_f32 v43, v23, s58, v43
    v_mfma_f32_16x16x32_bf16 a[48:51], a[184:187], v[168:171], a[48:51]
    v_cvt_pk_bf16_f32 v44, v40, v41
    v_cvt_pk_bf16_f32 v45, v42, v43
    v_mfma_f32_16x16x32_bf16 a[52:55], a[188:191], v[168:171], a[52:55]
    s_waitcnt vmcnt(13)
    global_store_dwordx2 v15, v[44:45], s[24:25]
    v_mfma_f32_16x16x32_bf16 v[16:19], a[192:195], v[172:175], v[16:19]
    v_add_u32 v15, 0x80000, v15
    v_mfma_f32_16x16x32_bf16 a[44:47], a[196:199], v[172:175], a[44:47]
    global_load_dwordx4 v[104:107], v5, s[28:29] offset:1024 sc1
    v_mfma_f32_16x16x32_bf16 a[48:51], a[200:203], v[172:175], a[48:51]
    v_mfma_f32_16x16x32_bf16 a[52:55], a[204:207], v[172:175], a[52:55]
    s_waitcnt vmcnt(14)
    ds_read_b64_tr_b16 v[36:37], v10 offset:32768
    v_mfma_f32_16x16x32_bf16 v[16:19], a[208:211], v[176:179], v[16:19]
    v_mfma_f32_16x16x32_bf16 a[44:47], a[212:215], v[176:179], a[44:47]
    global_load_dwordx4 v[108:111], v5, s[28:29] offset:2048 sc1
    v_mfma_f32_16x16x32_bf16 a[48:51], a[216:219], v[176:179], a[48:51]
    v_mfma_f32_16x16x32_bf16 a[52:55], a[220:223], v[176:179], a[52:55]
    s_waitcnt vmcnt(13)
    v_mfma_f32_16x16x32_bf16 v[16:19], a[224:227], v[180:183], v[16:19]
    v_mfma_f32_16x16x32_bf16 a[44:47], a[228:231], v[180:183], a[44:47]
    v_mfma_f32_16x16x32_bf16 a[48:51], a[232:235], v[180:183], a[48:51]
    v_mfma_f32_16x16x32_bf16 a[52:55], a[236:239], v[180:183], a[52:55]
    s_waitcnt vmcnt(12) lgkmcnt(0)
    v_lshlrev_b32 v40, 16, v36
    v_and_b32 v41, 0xffff0000, v36
    v_mfma_f32_16x16x32_bf16 v[16:19], a[240:243], v[184:187], v[16:19]
    v_lshlrev_b32 v42, 16, v37
    v_and_b32 v43, 0xffff0000, v37
    v_mfma_f32_16x16x32_bf16 a[44:47], a[244:247], v[184:187], a[44:47]
    v_mfma_f32_16x16x32_bf16 a[48:51], a[248:251], v[184:187], a[48:51]
    v_mfma_f32_16x16x32_bf16 a[52:55], a[252:255], v[184:187], a[52:55]
    s_waitcnt vmcnt(11)
    v_mfma_f32_16x16x32_bf16 v[20:23], a[80:83], v[68:71], 0
    v_mfma_f32_16x16x32_bf16 a[56:59], a[84:87], v[68:71], 0
    v_cmp_u_f32 vcc, v16, v16
    v_mfma_f32_16x16x32_bf16 a[60:63], a[88:91], v[68:71], 0
    s_cbranch_vccnz L_rf2
L_bf2:
    v_mfma_f32_16x16x32_bf16 a[64:67], a[92:95], v[68:71], 0
    s_waitcnt vmcnt(10)
    ds_write_b128 v6, a[44:47] offset:0
    v_mfma_f32_16x16x32_bf16 v[20:23], a[96:99], v[72:75], v[20:23]
    ds_write_b128 v6, a[48:51] offset:1024
    v_mfma_f32_16x16x32_bf16 a[56:59], a[100:103], v[72:75], a[56:59]
    ds_write_b128 v6, a[52:55] offset:2048
    v_mfma_f32_16x16x32_bf16 a[60:63], a[104:107], v[72:75], a[60:63]
    v_mfma_f32_16x16x32_bf16 a[64:67], a[108:111], v[72:75], a[64:67]
    s_waitcnt vmcnt(9)
    v_mfma_f32_16x16x32_bf16 v[20:23], a[112:115], v[76:79], v[20:23]
    v_mfma_f32_16x16x32_bf16 a[56:59], a[116:119], v[76:79], a[56:59]
    s_waitcnt lgkmcnt(0)
    s_barrier
    ds_read_b128 v[24:27], v7 offset:0
    ds_read_b128 v[28:31], v8 offset:0
    v_mfma_f32_16x16x32_bf16 a[60:63], a[120:123], v[76:79], a[60:63]
    ds_read_b128 v[32:35], v9 offset:0
    v_mfma_f32_16x16x32_bf16 a[64:67], a[124:127], v[76:79], a[64:67]
    s_waitcnt vmcnt(8)
    v_mfma_f32_16x16x32_bf16 v[20:23], a[128:131], v[80:83], v[20:23]
    v_mfma_f32_16x16x32_bf16 a[56:59], a[132:135], v[80:83], a[56:59]
    v_mfma_f32_16x16x32_bf16 a[60:63], a[136:139], v[80:83], a[60:63]
    v_mfma_f32_16x16x32_bf16 a[64:67], a[140:143], v[80:83], a[64:67]
    s_waitcnt vmcnt(7)
    v_mfma_f32_16x16x32_bf16 v[20:23], a[144:147], v[84:87], v[20:23]
    v_mfma_f32_16x16x32_bf16 a[56:59], a[148:151], v[84:87], a[56:59]
    s_waitcnt lgkmcnt(2)
    v_add_f32 v16, v16, v24
    v_add_f32 v17, v17, v25
    v_mfma_f32_16x16x32_bf16 a[60:63], a[152:155], v[84:87], a[60:63]
    v_add_f32 v18, v18, v26
    v_add_f32 v19, v19, v27
    v_mfma_f32_16x16x32_bf16 a[64:67], a[156:159], v[84:87], a[64:67]
    s_waitcnt vmcnt(6) lgkmcnt(1)
    v_add_f32 v16, v16, v28
    v_add_f32 v17, v17, v29
    v_mfma_f32_16x16x32_bf16 v[20:23], a[160:163], v[88:91], v[20:23]
    v_add_f32 v18, v18, v30
    v_add_f32 v19, v19, v31
    v_mfma_f32_16x16x32_bf16 a[56:59], a[164:167], v[88:91], a[56:59]
    s_waitcnt lgkmcnt(0)
    v_add_f32 v16, v16, v32
    v_add_f32 v17, v17, v33
    v_mfma_f32_16x16x32_bf16 a[60:63], a[168:171], v[88:91], a[60:63]
    v_add_f32 v18, v18, v34
    v_add_f32 v19, v19, v35
    v_mfma_f32_16x16x32_bf16 a[64:67], a[172:175], v[88:91], a[64:67]
    s_waitcnt vmcnt(5)
    v_fma_f32 v40, v16, s58, v40
    v_fma_f32 v41, v17, s58, v41
    v_mfma_f32_16x16x32_bf16 v[20:23], a[176:179], v[92:95], v[20:23]
    v_fma_f32 v42, v18, s58, v42
    v_fma_f32 v43, v19, s58, v43
    v_mfma_f32_16x16x32_bf16 a[56:59], a[180:183], v[92:95], a[56:59]
    v_cvt_pk_bf16_f32 v44, v40, v41
    v_cvt_pk_bf16_f32 v45, v42, v43
    v_mfma_f32_16x16x32_bf16 a[60:63], a[184:187], v[92:95], a[60:63]
    v_mfma_f32_16x16x32_bf16 a[64:67], a[188:191], v[92:95], a[64:67]
    s_waitcnt vmcnt(4)
    global_store_dwordx2 v15, v[44:45], s[24:25]
    v_mfma_f32_16x16x32_bf16 v[20:23], a[192:195], v[96:99], v[20:23]
    v_add_u32 v15, 0x80000, v15
    v_mfma_f32_16x16x32_bf16 a[56:59], a[196:199], v[96:99], a[56:59]
    v_mfma_f32_16x16x32_bf16 a[60:63], a[200:203], v[96:99], a[60:63]
    v_mfma_f32_16x16x32_bf16 a[64:67], a[204:207], v[96:99], a[64:67]
    s_waitcnt vmcnt(4)
    ds_read_b64_tr_b16 v[36:37], v10 offset:49152
    v_mfma_f32_16x16x32_bf16 v[20:23], a[208:211], v[100:103], v[20:23]
    v_mfma_f32_16x16x32_bf16 a[56:59], a[212:215], v[100:103], a[56:59]
    v_mfma_f32_16x16x32_bf16 a[60:63], a[216:219], v[100:103], a[60:63]
    v_mfma_f32_16x16x32_bf16 a[64:67], a[220:223], v[100:103], a[64:67]
    s_waitcnt vmcnt(2)
    v_mfma_f32_16x16x32_bf16 v[20:23], a[224:227], v[104:107], v[20:23]
    v_mfma_f32_16x16x32_bf16 a[56:59], a[228:231], v[104:107], a[56:59]
    v_mfma_f32_16x16x32_bf16 a[60:63], a[232:235], v[104:107], a[60:63]
    v_mfma_f32_16x16x32_bf16 a[64:67], a[236:239], v[104:107], a[64:67]
    s_waitcnt vmcnt(1) lgkmcnt(0)
    v_lshlrev_b32 v40, 16, v36
    v_and_b32 v41, 0xffff0000, v36
    v_mfma_f32_16x16x32_bf16 v[20:23], a[240:243], v[108:111], v[20:23]
    v_lshlrev_b32 v42, 16, v37
    v_and_b32 v43, 0xffff0000, v37
    v_mfma_f32_16x16x32_bf16 a[56:59], a[244:247], v[108:111], a[56:59]
    v_mfma_f32_16x16x32_bf16 a[60:63], a[248:251], v[108:111], a[60:63]
    v_mfma_f32_16x16x32_bf16 a[64:67], a[252:255], v[108:111], a[64:67]
    s_nop 2
    v_cmp_u_f32 vcc, v20, v20
    s_cbranch_vccnz L_rf3
L_bf3:
    s_nop 2
    ds_write_b128 v6, a[56:59] offset:12288
    ds_write_b128 v6, a[60:63] offset:13312
    ds_write_b128 v6, a[64:67] offset:14336
    s_waitcnt lgkmcnt(0)
    s_barrier
    ds_read_b128 v[24:27], v7 offset:12288
    ds_read_b128 v[28:31], v8 offset:12288
    ds_read_b128 v[32:35], v9 offset:12288
    s_waitcnt lgkmcnt(2)
    v_add_f32 v20, v20, v24
    v_add_f32 v21, v21, v25
    v_add_f32 v22, v22, v26
    v_add_f32 v23, v23, v27
    s_waitcnt lgkmcnt(1)
    v_add_f32 v20, v20, v28
    v_add_f32 v21, v21, v29
    v_add_f32 v22, v22, v30
    v_add_f32 v23, v23, v31
    s_waitcnt lgkmcnt(0)
    v_add_f32 v20, v20, v32
    v_add_f32 v21, v21, v33
    v_add_f32 v22, v22, v34
    v_add_f32 v23, v23, v35
    v_fma_f32 v40, v20, s58, v40
    v_fma_f32 v41, v21, s58, v41
    v_fma_f32 v42, v22, s58, v42
    v_fma_f32 v43, v23, s58, v43
    v_cvt_pk_bf16_f32 v44, v40, v41
    v_cvt_pk_bf16_f32 v45, v42, v43
    global_store_dwordx2 v15, v[44:45], s[24:25]
L_end:
    s_endpgm
L_rg0:
    s_cmp_eq_u32 s56, 0
    s_cbranch_scc1 L_bg0
    s_sub_u32 s56, s56, 1
    buffer_load_dwordx4 v[128:131], v9, s[48:51], s8 offen sc1
    buffer_load_dwordx4 v[112:115], v9, s[48:51], s16 offen sc1
    s_waitcnt vmcnt(0)
    v_perm_b32 v26, v129, v128, s54
    v_perm_b32 v27, v131, v130, s55
    v_or_b32 v26, v26, v27
    v_bitop3_b32 v26, v26, v114, s43 bitop3:0x7e
    v_cmp_ne_u32 vcc, 0, v26
    s_cbranch_vccnz L_rg0
    s_branch L_bg0
L_rw:
    s_cmp_eq_u32 s56, 0
    s_cbranch_scc1 L_bw
    s_sub_u32 s56, s56, 1
    global_load_dword v99, v10, s[28:29] sc1
    s_waitcnt vmcnt(0)
    v_cmp_ne_u32 vcc, s43, v99
    s_cbranch_vccnz L_rw
    s_branch L_bw
L_rg1:
    s_cmp_eq_u32 s56, 0
    s_cbranch_scc1 L_bg1
    s_sub_u32 s56, s56, 1
    buffer_load_dwordx4 v[132:135], v9, s[48:51], s9 offen sc1
    buffer_load_dwordx4 v[116:119], v9, s[48:51], s17 offen sc1
    s_waitcnt vmcnt(0)
    v_perm_b32 v96, v133, v132, s54
    v_perm_b32 v97, v135, v134, s55
    v_or_b32 v96, v96, v97
    v_bitop3_b32 v96, v96, v118, s43 bitop3:0x7e
    v_cmp_ne_u32 vcc, 0, v96
    s_cbranch_vccnz L_rg1
    s_branch L_bg1
L_rg2:
    s_cmp_eq_u32 s56, 0
    s_cbranch_scc1 L_bg2
    s_sub_u32 s56, s56, 1
    buffer_load_dwordx4 v[136:139], v9, s[48:51], s10 offen sc1
    buffer_load_dwordx4 v[120:123], v9, s[48:51], s18 offen sc1
    s_waitcnt vmcnt(0)
    v_perm_b32 v96, v137, v136, s54
    v_perm_b32 v97, v139, v138, s55
    v_or_b32 v96, v96, v97
    v_bitop3_b32 v96, v96, v122, s43 bitop3:0x7e
    v_cmp_ne_u32 vcc, 0, v96
    s_cbranch_vccnz L_rg2
    s_branch L_bg2
L_rg3:
    s_cmp_eq_u32 s56, 0
    s_cbranch_scc1 L_bg3
    s_sub_u32 s56, s56, 1
    buffer_load_dwordx4 v[140:143], v9, s[48:51], s11 offen sc1
    buffer_load_dwordx4 v[124:127], v9, s[48:51], s19 offen sc1
    s_waitcnt vmcnt(0)
    v_perm_b32 v96, v141, v140, s54
    v_perm_b32 v97, v143, v142, s55
    v_or_b32 v96, v96, v97
    v_bitop3_b32 v96, v96, v126, s43 bitop3:0x7e
    v_cmp_ne_u32 vcc, 0, v96
    s_cbranch_vccnz L_rg3
    s_branch L_bg3
L_rh0:
    s_cmp_eq_u32 s56, 0
    s_cbranch_scc1 L_bh0
    s_sub_u32 s56, s56, 1
    v_subrev_u32 v101, 0x4000, v11
    global_load_dwordx4 v[68:71], v101, s[28:29] offset:0 sc1
    global_load_dwordx4 v[72:75], v101, s[28:29] offset:1024 sc1
    global_load_dwordx4 v[76:79], v101, s[28:29] offset:2048 sc1
    global_load_dwordx4 v[80:83], v101, s[28:29] offset:3072 sc1
    s_waitcnt vmcnt(0)
    v_max3_u32 v100, v68, v69, v70
    v_max3_u32 v100, v100, v71, v72
    v_max3_u32 v100, v100, v73, v74
    v_max3_u32 v100, v100, v75, v76
    v_max3_u32 v100, v100, v77, v78
    v_max3_u32 v100, v100, v79, v80
    v_max3_u32 v100, v100, v81, v82
    v_max_u32 v100, v100, v83
    v_cmp_eq_u32 vcc, -1, v100
    s_cbranch_vccnz L_rh0
    s_branch L_bh0
L_rh1a:
    s_cmp_eq_u32 s56, 0
    s_cbranch_scc1 L_bh1a
    s_sub_u32 s56, s56, 1
    v_subrev_u32 v101, 0x4000, v11
    global_load_dwordx4 v[84:87], v101, s[28:29] offset:0 sc1
    global_load_dwordx4 v[88:91], v101, s[28:29] offset:1024 sc1
    global_load_dwordx4 v[92:95], v101, s[28:29] offset:2048 sc1
    global_load_dwordx4 v[96:99], v101, s[28:29] offset:3072 sc1
    s_waitcnt vmcnt(0)
    v_max3_u32 v100, v84, v85, v86
    v_max3_u32 v100, v100, v87, v88
    v_max3_u32 v100, v100, v89, v90
    v_max3_u32 v100, v100, v91, v92
    v_max3_u32 v100, v100, v93, v94
    v_max3_u32 v100, v100, v95, v96
    v_max3_u32 v100, v100, v97, v98
    v_max_u32 v100, v100, v99
    v_cmp_eq_u32 vcc, -1, v100
    s_cbranch_vccnz L_rh1a
    s_branch L_bh1a
L_rh2a:
    s_cmp_eq_u32 s56, 0
    s_cbranch_scc1 L_bh2a
    s_sub_u32 s56, s56, 1
    v_subrev_u32 v101, 0x4000, v11
    global_load_dwordx4 v[68:71], v101, s[28:29] offset:0 sc1
    global_load_dwordx4 v[72:75], v101, s[28:29] offset:1024 sc1
    global_load_dwordx4 v[76:79], v101, s[28:29] offset:2048 sc1
    global_load_dwordx4 v[80:83], v101, s[28:29] offset:3072 sc1
    s_waitcnt vmcnt(0)
    v_max3_u32 v100, v68, v69, v70
    v_max3_u32 v100, v100, v71, v72
    v_max3_u32 v100, v100, v73, v74
    v_max3_u32 v100, v100, v75, v76
    v_max3_u32 v100, v100, v77, v78
    v_max3_u32 v100, v100, v79, v80
    v_max3_u32 v100, v100, v81, v82
    v_max_u32 v100, v100, v83
    v_cmp_eq_u32 vcc, -1, v100
    s_cbranch_vccnz L_rh2a
    s_branch L_bh2a
L_rh3a:
    s_cmp_eq_u32 s56, 0
    s_cbranch_scc1 L_bh3a
    s_sub_u32 s56, s56, 1
    v_subrev_u32 v101, 0x0, v11
    global_load_dwordx4 v[84:87], v101, s[28:29] offset:0 sc1
    global_load_dwordx4 v[88:91], v101, s[28:29] offset:1024 sc1
    global_load_dwordx4 v[92:95], v101, s[28:29] offset:2048 sc1
    global_load_dwordx4 v[96:99], v101, s[28:29] offset:3072 sc1
    s_waitcnt vmcnt(0)
    v_max3_u32 v100, v84, v85, v86
    v_max3_u32 v100, v100, v87, v88
    v_max3_u32 v100, v100, v89, v90
    v_max3_u32 v100, v100, v91, v92
    v_max3_u32 v100, v100, v93, v94
    v_max3_u32 v100, v100, v95, v96
    v_max3_u32 v100, v100, v97, v98
    v_max_u32 v100, v100, v99
    v_cmp_eq_u32 vcc, -1, v100
    s_cbranch_vccnz L_rh3a
    s_branch L_bh3a
L_rw2a:
    s_cmp_eq_u32 s56, 0
    s_cbranch_scc1 L_bw2a
    s_sub_u32 s56, s56, 1
    global_load_dword v125, v124, s[28:29] sc1
    s_waitcnt vmcnt(0)
    v_cmp_ne_u32 vcc, s43, v125
    s_cbranch_vccnz L_rw2a
    s_branch L_bw2a
L_rh1b:
    s_cmp_eq_u32 s56, 0
    s_cbranch_scc1 L_bh1b
    s_sub_u32 s56, s56, 1
    v_subrev_u32 v101, 0x4000, v11
    global_load_dwordx4 v[84:87], v101, s[28:29] offset:0 sc1
    global_load_dwordx4 v[88:91], v101, s[28:29] offset:1024 sc1
    global_load_dwordx4 v[92:95], v101, s[28:29] offset:2048 sc1
    global_load_dwordx4 v[96:99], v101, s[28:29] offset:3072 sc1
    s_waitcnt vmcnt(0)
    v_max3_u32 v100, v84, v85, v86
    v_max3_u32 v100, v100, v87, v88
    v_max3_u32 v100, v100, v89, v90
    v_max3_u32 v100, v100, v91, v92
    v_max3_u32 v100, v100, v93, v94
    v_max3_u32 v100, v100, v95, v96
    v_max3_u32 v100, v100, v97, v98
    v_max_u32 v100, v100, v99
    v_cmp_eq_u32 vcc, -1, v100
    s_cbranch_vccnz L_rh1b
    s_branch L_bh1b
L_rh2b:
    s_cmp_eq_u32 s56, 0
    s_cbranch_scc1 L_bh2b
    s_sub_u32 s56, s56, 1
    v_subrev_u32 v101, 0x4000, v11
    global_load_dwordx4 v[68:71], v101, s[28:29] offset:0 sc1
    global_load_dwordx4 v[72:75], v101, s[28:29] offset:1024 sc1
    global_load_dwordx4 v[76:79], v101, s[28:29] offset:2048 sc1
    global_load_dwordx4 v[80:83], v101, s[28:29] offset:3072 sc1
    s_waitcnt vmcnt(0)
    v_max3_u32 v100, v68, v69, v70
    v_max3_u32 v100, v100, v71, v72
    v_max3_u32 v100, v100, v73, v74
    v_max3_u32 v100, v100, v75, v76
    v_max3_u32 v100, v100, v77, v78
    v_max3_u32 v100, v100, v79, v80
    v_max3_u32 v100, v100, v81, v82
    v_max_u32 v100, v100, v83
    v_cmp_eq_u32 vcc, -1, v100
    s_cbranch_vccnz L_rh2b
    s_branch L_bh2b
L_rh3b:
    s_cmp_eq_u32 s56, 0
    s_cbranch_scc1 L_bh3b
    s_sub_u32 s56, s56, 1
    v_subrev_u32 v101, 0x0, v11
    global_load_dwordx4 v[84:87], v101, s[28:29] offset:0 sc1
    global_load_dwordx4 v[88:91], v101, s[28:29] offset:1024 sc1
    global_load_dwordx4 v[92:95], v101, s[28:29] offset:2048 sc1
    global_load_dwordx4 v[96:99], v101, s[28:29] offset:3072 sc1
    s_waitcnt vmcnt(0)
    v_max3_u32 v100, v84, v85, v86
    v_max3_u32 v100, v100, v87, v88
    v_max3_u32 v100, v100, v89, v90
    v_max3_u32 v100, v100, v91, v92
    v_max3_u32 v100, v100, v93, v94
    v_max3_u32 v100, v100, v95, v96
    v_max3_u32 v100, v100, v97, v98
    v_max_u32 v100, v100, v99
    v_cmp_eq_u32 vcc, -1, v100
    s_cbranch_vccnz L_rh3b
    s_branch L_bh3b
L_rw2b:
    s_cmp_eq_u32 s56, 0
    s_cbranch_scc1 L_bw2b
    s_sub_u32 s56, s56, 1
    global_load_dword v125, v124, s[28:29] sc1
    s_waitcnt vmcnt(0)
    v_cmp_ne_u32 vcc, s43, v125
    s_cbranch_vccnz L_rw2b
    s_branch L_bw2b
L_rf0:
    s_cmp_eq_u32 s56, 0
    s_cbranch_scc1 L_bf0
    s_sub_u32 s56, s56, 1
    s_add_u32 s12, s63, 0
    v_lshl_add_u32 v46, v1, 4, s12
    global_load_dwordx4 v[68:71], v46, s[28:29] offset:-4096 sc1
    global_load_dwordx4 v[72:75], v46, s[28:29] offset:-3072 sc1
    global_load_dwordx4 v[76:79], v46, s[28:29] offset:-2048 sc1
    global_load_dwordx4 v[80:83], v46, s[28:29] offset:-1024 sc1
    global_load_dwordx4 v[84:87], v46, s[28:29] offset:0 sc1
    global_load_dwordx4 v[88:91], v46, s[28:29] offset:1024 sc1
    global_load_dwordx4 v[92:95], v46, s[28:29] offset:2048 sc1
    global_load_dwordx4 v[96:99], v46, s[28:29] offset:3072 sc1
    v_add_u32 v46, 0x1000, v46
    global_load_dwordx4 v[100:103], v46, s[28:29] offset:0 sc1
    global_load_dwordx4 v[104:107], v46, s[28:29] offset:1024 sc1
    global_load_dwordx4 v[108:111], v46, s[28:29] offset:2048 sc1
    s_add_u32 s12, s63, 180224
    v_lshl_add_u32 v46, v1, 4, s12
    global_load_dwordx4 a[0:3], v46, s[28:29] offset:-4096 sc1
    global_load_dwordx4 a[4:7], v46, s[28:29] offset:-3072 sc1
    global_load_dwordx4 a[8:11], v46, s[28:29] offset:-2048 sc1
    global_load_dwordx4 a[12:15], v46, s[28:29] offset:-1024 sc1
    global_load_dwordx4 a[16:19], v46, s[28:29] offset:0 sc1
    global_load_dwordx4 a[20:23], v46, s[28:29] offset:1024 sc1
    global_load_dwordx4 a[24:27], v46, s[28:29] offset:2048 sc1
    global_load_dwordx4 a[28:31], v46, s[28:29] offset:3072 sc1
    v_add_u32 v46, 0x1000, v46
    global_load_dwordx4 a[32:35], v46, s[28:29] offset:0 sc1
    global_load_dwordx4 a[36:39], v46, s[28:29] offset:1024 sc1
    global_load_dwordx4 a[40:43], v46, s[28:29] offset:2048 sc1
    s_add_u32 s12, s63, 360448
    v_lshl_add_u32 v46, v1, 4, s12
    global_load_dwordx4 v[144:147], v46, s[28:29] offset:-4096 sc1
    global_load_dwordx4 v[148:151], v46, s[28:29] offset:-3072 sc1
    s_waitcnt vmcnt(13)
    v_mfma_f32_16x16x32_bf16 v[16:19], a[80:83], v[68:71], 0
    v_mfma_f32_16x16x32_bf16 a[44:47], a[84:87], v[68:71], 0
    v_mfma_f32_16x16x32_bf16 a[48:51], a[88:91], v[68:71], 0
    v_mfma_f32_16x16x32_bf16 a[52:55], a[92:95], v[68:71], 0
    v_mfma_f32_16x16x32_bf16 v[16:19], a[96:99], v[72:75], v[16:19]
    v_mfma_f32_16x16x32_bf16 a[44:47], a[100:103], v[72:75], a[44:47]
    v_mfma_f32_16x16x32_bf16 a[48:51], a[104:107], v[72:75], a[48:51]
    v_mfma_f32_16x16x32_bf16 a[52:55], a[108:111], v[72:75], a[52:55]
    v_mfma_f32_16x16x32_bf16 v[16:19], a[112:115], v[76:79], v[16:19]
    v_mfma_f32_16x16x32_bf16 a[44:47], a[116:119], v[76:79], a[44:47]
    v_mfma_f32_16x16x32_bf16 a[48:51], a[120:123], v[76:79], a[48:51]
    v_mfma_f32_16x16x32_bf16 a[52:55], a[124:127], v[76:79], a[52:55]
    v_mfma_f32_16x16x32_bf16 v[16:19], a[128:131], v[80:83], v[16:19]
    v_mfma_f32_16x16x32_bf16 a[44:47], a[132:135], v[80:83], a[44:47]
    v_mfma_f32_16x16x32_bf16 a[48:51], a[136:139], v[80:83], a[48:51]
    v_mfma_f32_16x16x32_bf16 a[52:55], a[140:143], v[80:83], a[52:55]
    v_mfma_f32_16x16x32_bf16 v[16:19], a[144:147], v[84:87], v[16:19]
    v_mfma_f32_16x16x32_bf16 a[44:47], a[148:151], v[84:87], a[44:47]
    v_mfma_f32_16x16x32_bf16 a[48:51], a[152:155], v[84:87], a[48:51]
    v_mfma_f32_16x16x32_bf16 a[52:55], a[156:159], v[84:87], a[52:55]
    v_mfma_f32_16x16x32_bf16 v[16:19], a[160:163], v[88:91], v[16:19]
    v_mfma_f32_16x16x32_bf16 a[44:47], a[164:167], v[88:91], a[44:47]
    v_mfma_f32_16x16x32_bf16 a[48:51], a[168:171], v[88:91], a[48:51]
    v_mfma_f32_16x16x32_bf16 a[52:55], a[172:175], v[88:91], a[52:55]
    v_mfma_f32_16x16x32_bf16 v[16:19], a[176:179], v[92:95], v[16:19]
    v_mfma_f32_16x16x32_bf16 a[44:47], a[180:183], v[92:95], a[44:47]
    v_mfma_f32_16x16x32_bf16 a[48:51], a[184:187], v[92:95], a[48:51]
    v_mfma_f32_16x16x32_bf16 a[52:55], a[188:191], v[92:95], a[52:55]
    v_mfma_f32_16x16x32_bf16 v[16:19], a[192:195], v[96:99], v[16:19]
    v_mfma_f32_16x16x32_bf16 a[44:47], a[196:199], v[96:99], a[44:47]
    v_mfma_f32_16x16x32_bf16 a[48:51], a[200:203], v[96:99], a[48:51]
    v_mfma_f32_16x16x32_bf16 a[52:55], a[204:207], v[96:99], a[52:55]
    v_mfma_f32_16x16x32_bf16 v[16:19], a[208:211], v[100:103], v[16:19]
    v_mfma_f32_16x16x32_bf16 a[44:47], a[212:215], v[100:103], a[44:47]
    v_mfma_f32_16x16x32_bf16 a[48:51], a[216:219], v[100:103], a[48:51]
    v_mfma_f32_16x16x32_bf16 a[52:55], a[220:223], v[100:103], a[52:55]
    v_mfma_f32_16x16x32_bf16 v[16:19], a[224:227], v[104:107], v[16:19]
    v_mfma_f32_16x16x32_bf16 a[44:47], a[228:231], v[104:107], a[44:47]
    v_mfma_f32_16x16x32_bf16 a[48:51], a[232:235], v[104:107], a[48:51]
    v_mfma_f32_16x16x32_bf16 a[52:55], a[236:239], v[104:107], a[52:55]
    v_mfma_f32_16x16x32_bf16 v[16:19], a[240:243], v[108:111], v[16:19]
    v_mfma_f32_16x16x32_bf16 a[44:47], a[244:247], v[108:111], a[44:47]
    v_mfma_f32_16x16x32_bf16 a[48:51], a[248:251], v[108:111], a[48:51]
    v_mfma_f32_16x16x32_bf16 a[52:55], a[252:255], v[108:111], a[52:55]
    s_waitcnt vmcnt(0)
    v_mfma_f32_16x16x32_bf16 v[20:23], a[80:83], a[0:3], 0
    v_mfma_f32_16x16x32_bf16 a[56:59], a[84:87], a[0:3], 0
    v_mfma_f32_16x16x32_bf16 a[60:63], a[88:91], a[0:3], 0
    v_mfma_f32_16x16x32_bf16 a[64:67], a[92:95], a[0:3], 0
    v_cmp_u_f32 vcc, v16, v16
    s_cbranch_vccnz L_rf0
    s_branch L_bf0
L_rf1:
    s_cmp_eq_u32 s56, 0
    s_cbranch_scc1 L_bf1
    s_sub_u32 s56, s56, 1
    s_add_u32 s12, s63, 180224
    v_lshl_add_u32 v46, v1, 4, s12
    global_load_dwordx4 a[0:3], v46, s[28:29] offset:-4096 sc1
    global_load_dwordx4 a[4:7], v46, s[28:29] offset:-3072 sc1
    global_load_dwordx4 a[8:11], v46, s[28:29] offset:-2048 sc1
    global_load_dwordx4 a[12:15], v46, s[28:29] offset:-1024 sc1
    global_load_dwordx4 a[16:19], v46, s[28:29] offset:0 sc1
    global_load_dwordx4 a[20:23], v46, s[28:29] offset:1024 sc1
    global_load_dwordx4 a[24:27], v46, s[28:29] offset:2048 sc1
    global_load_dwordx4 a[28:31], v46, s[28:29] offset:3072 sc1
    v_add_u32 v46, 0x1000, v46
    global_load_dwordx4 a[32:35], v46, s[28:29] offset:0 sc1
    global_load_dwordx4 a[36:39], v46, s[28:29] offset:1024 sc1
    global_load_dwordx4 a[40:43], v46, s[28:29] offset:2048 sc1
    s_add_u32 s12, s63, 360448
    v_lshl_add_u32 v46, v1, 4, s12
    global_load_dwordx4 v[144:147], v46, s[28:29] offset:-4096 sc1
    global_load_dwordx4 v[148:151], v46, s[28:29] offset:-3072 sc1
    global_load_dwordx4 v[152:155], v46, s[28:29] offset:-2048 sc1
    global_load_dwordx4 v[156:159], v46, s[28:29] offset:-1024 sc1
    global_load_dwordx4 v[160:163], v46, s[28:29] offset:0 sc1
    global_load_dwordx4 v[164:167], v46, s[28:29] offset:1024 sc1
    global_load_dwordx4 v[168:171], v46, s[28:29] offset:2048 sc1
    global_load_dwordx4 v[172:175], v46, s[28:29] offset:3072 sc1
    v_add_u32 v46, 0x1000, v46
    global_load_dwordx4 v[176:179], v46, s[28:29] offset:0 sc1
    global_load_dwordx4 v[180:183], v46, s[28:29] offset:1024 sc1
    global_load_dwordx4 v[184:187], v46, s[28:29] offset:2048 sc1
    s_add_u32 s12, s63, 540672
    v_lshl_add_u32 v46, v1, 4, s12
    global_load_dwordx4 v[68:71], v46, s[28:29] offset:-4096 sc1
    global_load_dwordx4 v[72:75], v46, s[28:29] offset:-3072 sc1
    s_waitcnt vmcnt(13)
    v_mfma_f32_16x16x32_bf16 v[20:23], a[80:83], a[0:3], 0
    v_mfma_f32_16x16x32_bf16 a[56:59], a[84:87], a[0:3], 0
    v_mfma_f32_16x16x32_bf16 a[60:63], a[88:91], a[0:3], 0
    v_mfma_f32_16x16x32_bf16 a[64:67], a[92:95], a[0:3], 0
    v_mfma_f32_16x16x32_bf16 v[20:23], a[96:99], a[4:7], v[20:23]
    v_mfma_f32_16x16x32_bf16 a[56:59], a[100:103], a[4:7], a[56:59]
    v_mfma_f32_16x16x32_bf16 a[60:63], a[104:107], a[4:7], a[60:63]
    v_mfma_f32_16x16x32_bf16 a[64:67], a[108:111], a[4:7], a[64:67]
    v_mfma_f32_16x16x32_bf16 v[20:23], a[112:115], a[8:11], v[20:23]
    v_mfma_f32_16x16x32_bf16 a[56:59], a[116:119], a[8:11], a[56:59]
    v_mfma_f32_16x16x32_bf16 a[60:63], a[120:123], a[8:11], a[60:63]
    v_mfma_f32_16x16x32_bf16 a[64:67], a[124:127], a[8:11], a[64:67]
    v_mfma_f32_16x16x32_bf16 v[20:23], a[128:131], a[12:15], v[20:23]
    v_mfma_f32_16x16x32_bf16 a[56:59], a[132:135], a[12:15], a[56:59]
    v_mfma_f32_16x16x32_bf16 a[60:63], a[136:139], a[12:15], a[60:63]
    v_mfma_f32_16x16x32_bf16 a[64:67], a[140:143], a[12:15], a[64:67]
    v_mfma_f32_16x16x32_bf16 v[20:23], a[144:147], a[16:19], v[20:23]
    v_mfma_f32_16x16x32_bf16 a[56:59], a[148:151], a[16:19], a[56:59]
    v_mfma_f32_16x16x32_bf16 a[60:63], a[152:155], a[16:19], a[60:63]
    v_mfma_f32_16x16x32_bf16 a[64:67], a[156:159], a[16:19], a[64:67]
    v_mfma_f32_16x16x32_bf16 v[20:23], a[160:163], a[20:23], v[20:23]
    v_mfma_f32_16x16x32_bf16 a[56:59], a[164:167], a[20:23], a[56:59]
    v_mfma_f32_16x16x32_bf16 a[60:63], a[168:171], a[20:23], a[60:63]
    v_mfma_f32_16x16x32_bf16 a[64:67], a[172:175], a[20:23], a[64:67]
    v_mfma_f32_16x16x32_bf16 v[20:23], a[176:179], a[24:27], v[20:23]
    v_mfma_f32_16x16x32_bf16 a[56:59], a[180:183], a[24:27], a[56:59]
    v_mfma_f32_16x16x32_bf16 a[60:63], a[184:187], a[24:27], a[60:63]
    v_mfma_f32_16x16x32_bf16 a[64:67], a[188:191], a[24:27], a[64:67]
    v_mfma_f32_16x16x32_bf16 v[20:23], a[192:195], a[28:31], v[20:23]
    v_mfma_f32_16x16x32_bf16 a[56:59], a[196:199], a[28:31], a[56:59]
    v_mfma_f32_16x16x32_bf16 a[60:63], a[200:203], a[28:31], a[60:63]
    v_mfma_f32_16x16x32_bf16 a[64:67], a[204:207], a[28:31], a[64:67]
    v_mfma_f32_16x16x32_bf16 v[20:23], a[208:211], a[32:35], v[20:23]
    v_mfma_f32_16x16x32_bf16 a[56:59], a[212:215], a[32:35], a[56:59]
    v_mfma_f32_16x16x32_bf16 a[60:63], a[216:219], a[32:35], a[60:63]
    v_mfma_f32_16x16x32_bf16 a[64:67], a[220:223], a[32:35], a[64:67]
    v_mfma_f32_16x16x32_bf16 v[20:23], a[224:227], a[36:39], v[20:23]
    v_mfma_f32_16x16x32_bf16 a[56:59], a[228:231], a[36:39], a[56:59]
    v_mfma_f32_16x16x32_bf16 a[60:63], a[232:235], a[36:39], a[60:63]
    v_mfma_f32_16x16x32_bf16 a[64:67], a[236:239], a[36:39], a[64:67]
    v_mfma_f32_16x16x32_bf16 v[20:23], a[240:243], a[40:43], v[20:23]
    v_mfma_f32_16x16x32_bf16 a[56:59], a[244:247], a[40:43], a[56:59]
    v_mfma_f32_16x16x32_bf16 a[60:63], a[248:251], a[40:43], a[60:63]
    v_mfma_f32_16x16x32_bf16 a[64:67], a[252:255], a[40:43], a[64:67]
    s_waitcnt vmcnt(0)
    v_mfma_f32_16x16x32_bf16 v[16:19], a[80:83], v[144:147], 0
    v_mfma_f32_16x16x32_bf16 a[44:47], a[84:87], v[144:147], 0
    s_nop 1
    v_cmp_u_f32 vcc, v20, v20
    s_cbranch_vccnz L_rf1
    s_branch L_bf1
L_rf2:
    s_cmp_eq_u32 s56, 0
    s_cbranch_scc1 L_bf2
    s_sub_u32 s56, s56, 1
    s_add_u32 s12, s63, 360448
    v_lshl_add_u32 v46, v1, 4, s12
    global_load_dwordx4 v[144:147], v46, s[28:29] offset:-4096 sc1
    global_load_dwordx4 v[148:151], v46, s[28:29] offset:-3072 sc1
    global_load_dwordx4 v[152:155], v46, s[28:29] offset:-2048 sc1
    global_load_dwordx4 v[156:159], v46, s[28:29] offset:-1024 sc1
    global_load_dwordx4 v[160:163], v46, s[28:29] offset:0 sc1
    global_load_dwordx4 v[164:167], v46, s[28:29] offset:1024 sc1
    global_load_dwordx4 v[168:171], v46, s[28:29] offset:2048 sc1
    global_load_dwordx4 v[172:175], v46, s[28:29] offset:3072 sc1
    v_add_u32 v46, 0x1000, v46
    global_load_dwordx4 v[176:179], v46, s[28:29] offset:0 sc1
    global_load_dwordx4 v[180:183], v46, s[28:29] offset:1024 sc1
    global_load_dwordx4 v[184:187], v46, s[28:29] offset:2048 sc1
    s_add_u32 s12, s63, 540672
    v_lshl_add_u32 v46, v1, 4, s12
    global_load_dwordx4 v[68:71], v46, s[28:29] offset:-4096 sc1
    global_load_dwordx4 v[72:75], v46, s[28:29] offset:-3072 sc1
    global_load_dwordx4 v[76:79], v46, s[28:29] offset:-2048 sc1
    global_load_dwordx4 v[80:83], v46, s[28:29] offset:-1024 sc1
    global_load_dwordx4 v[84:87], v46, s[28:29] offset:0 sc1
    global_load_dwordx4 v[88:91], v46, s[28:29] offset:1024 sc1
    global_load_dwordx4 v[92:95], v46, s[28:29] offset:2048 sc1
    global_load_dwordx4 v[96:99], v46, s[28:29] offset:3072 sc1
    v_add_u32 v46, 0x1000, v46
    global_load_dwordx4 v[100:103], v46, s[28:29] offset:0 sc1
    global_load_dwordx4 v[104:107], v46, s[28:29] offset:1024 sc1
    global_load_dwordx4 v[108:111], v46, s[28:29] offset:2048 sc1
    s_waitcnt vmcnt(11)
    v_mfma_f32_16x16x32_bf16 v[16:19], a[80:83], v[144:147], 0
    v_mfma_f32_16x16x32_bf16 a[44:47], a[84:87], v[144:147], 0
    v_mfma_f32_16x16x32_bf16 a[48:51], a[88:91], v[144:147], 0
    v_mfma_f32_16x16x32_bf16 a[52:55], a[92:95], v[144:147], 0
    v_mfma_f32_16x16x32_bf16 v[16:19], a[96:99], v[148:151], v[16:19]
    v_mfma_f32_16x16x32_bf16 a[44:47], a[100:103], v[148:151], a[44:47]
    v_mfma_f32_16x16x32_bf16 a[48:51], a[104:107], v[148:151], a[48:51]
    v_mfma_f32_16x16x32_bf16 a[52:55], a[108:111], v[148:151], a[52:55]
    v_mfma_f32_16x16x32_bf16 v[16:19], a[112:115], v[152:155], v[16:19]
    v_mfma_f32_16x16x32_bf16 a[44:47], a[116:119], v[152:155], a[44:47]
    v_mfma_f32_16x16x32_bf16 a[48:51], a[120:123], v[152:155], a[48:51]
    v_mfma_f32_16x16x32_bf16 a[52:55], a[124:127], v[152:155], a[52:55]
    v_mfma_f32_16x16x32_bf16 v[16:19], a[128:131], v[156:159], v[16:19]
    v_mfma_f32_16x16x32_bf16 a[44:47], a[132:135], v[156:159], a[44:47]
    v_mfma_f32_16x16x32_bf16 a[48:51], a[136:139], v[156:159], a[48:51]
    v_mfma_f32_16x16x32_bf16 a[52:55], a[140:143], v[156:159], a[52:55]
    v_mfma_f32_16x16x32_bf16 v[16:19], a[144:147], v[160:163], v[16:19]
    v_mfma_f32_16x16x32_bf16 a[44:47], a[148:151], v[160:163], a[44:47]
    v_mfma_f32_16x16x32_bf16 a[48:51], a[152:155], v[160:163], a[48:51]
    v_mfma_f32_16x16x32_bf16 a[52:55], a[156:159], v[160:163], a[52:55]
    v_mfma_f32_16x16x32_bf16 v[16:19], a[160:163], v[164:167], v[16:19]
    v_mfma_f32_16x16x32_bf16 a[44:47], a[164:167], v[164:167], a[44:47]
    v_mfma_f32_16x16x32_bf16 a[48:51], a[168:171], v[164:167], a[48:51]
    v_mfma_f32_16x16x32_bf16 a[52:55], a[172:175], v[164:167], a[52:55]
    v_mfma_f32_16x16x32_bf16 v[16:19], a[176:179], v[168:171], v[16:19]
    v_mfma_f32_16x16x32_bf16 a[44:47], a[180:183], v[168:171], a[44:47]
    v_mfma_f32_16x16x32_bf16 a[48:51], a[184:187], v[168:171], a[48:51]
    v_mfma_f32_16x16x32_bf16 a[52:55], a[188:191], v[168:171], a[52:55]
    v_mfma_f32_16x16x32_bf16 v[16:19], a[192:195], v[172:175], v[16:19]
    v_mfma_f32_16x16x32_bf16 a[44:47], a[196:199], v[172:175], a[44:47]
    v_mfma_f32_16x16x32_bf16 a[48:51], a[200:203], v[172:175], a[48:51]
    v_mfma_f32_16x16x32_bf16 a[52:55], a[204:207], v[172:175], a[52:55]
    v_mfma_f32_16x16x32_bf16 v[16:19], a[208:211], v[176:179], v[16:19]
    v_mfma_f32_16x16x32_bf16 a[44:47], a[212:215], v[176:179], a[44:47]
    v_mfma_f32_16x16x32_bf16 a[48:51], a[216:219], v[176:179], a[48:51]
    v_mfma_f32_16x16x32_bf16 a[52:55], a[220:223], v[176:179], a[52:55]
    v_mfma_f32_16x16x32_bf16 v[16:19], a[224:227], v[180:183], v[16:19]
    v_mfma_f32_16x16x32_bf16 a[44:47], a[228:231], v[180:183], a[44:47]
    v_mfma_f32_16x16x32_bf16 a[48:51], a[232:235], v[180:183], a[48:51]
    v_mfma_f32_16x16x32_bf16 a[52:55], a[236:239], v[180:183], a[52:55]
    v_mfma_f32_16x16x32_bf16 v[16:19], a[240:243], v[184:187], v[16:19]
    v_mfma_f32_16x16x32_bf16 a[44:47], a[244:247], v[184:187], a[44:47]
    v_mfma_f32_16x16x32_bf16 a[48:51], a[248:251], v[184:187], a[48:51]
    v_mfma_f32_16x16x32_bf16 a[52:55], a[252:255], v[184:187], a[52:55]
    s_waitcnt vmcnt(0)
    v_mfma_f32_16x16x32_bf16 v[20:23], a[80:83], v[68:71], 0
    v_mfma_f32_16x16x32_bf16 a[56:59], a[84:87], v[68:71], 0
    v_mfma_f32_16x16x32_bf16 a[60:63], a[88:91], v[68:71], 0
    s_nop 0
    v_cmp_u_f32 vcc, v16, v16
    s_cbranch_vccnz L_rf2
    s_branch L_bf2
L_rf3:
    s_cmp_eq_u32 s56, 0
    s_cbranch_scc1 L_bf3
    s_sub_u32 s56, s56, 1
    s_add_u32 s12, s63, 540672
    v_lshl_add_u32 v46, v1, 4, s12
    global_load_dwordx4 v[68:71], v46, s[28:29] offset:-4096 sc1
    global_load_dwordx4 v[72:75], v46, s[28:29] offset:-3072 sc1
    global_load_dwordx4 v[76:79], v46, s[28:29] offset:-2048 sc1
    global_load_dwordx4 v[80:83], v46, s[28:29] offset:-1024 sc1
    global_load_dwordx4 v[84:87], v46, s[28:29] offset:0 sc1
    global_load_dwordx4 v[88:91], v46, s[28:29] offset:1024 sc1
    global_load_dwordx4 v[92:95], v46, s[28:29] offset:2048 sc1
    global_load_dwordx4 v[96:99], v46, s[28:29] offset:3072 sc1
    v_add_u32 v46, 0x1000, v46
    global_load_dwordx4 v[100:103], v46, s[28:29] offset:0 sc1
    global_load_dwordx4 v[104:107], v46, s[28:29] offset:1024 sc1
    global_load_dwordx4 v[108:111], v46, s[28:29] offset:2048 sc1
    s_waitcnt vmcnt(0)
    v_mfma_f32_16x16x32_bf16 v[20:23], a[80:83], v[68:71], 0
    v_mfma_f32_16x16x32_bf16 a[56:59], a[84:87], v[68:71], 0
    v_mfma_f32_16x16x32_bf16 a[60:63], a[88:91], v[68:71], 0
    v_mfma_f32_16x16x32_bf16 a[64:67], a[92:95], v[68:71], 0
    v_mfma_f32_16x16x32_bf16 v[20:23], a[96:99], v[72:75], v[20:23]
    v_mfma_f32_16x16x32_bf16 a[56:59], a[100:103], v[72:75], a[56:59]
    v_mfma_f32_16x16x32_bf16 a[60:63], a[104:107], v[72:75], a[60:63]
    v_mfma_f32_16x16x32_bf16 a[64:67], a[108:111], v[72:75], a[64:67]
    v_mfma_f32_16x16x32_bf16 v[20:23], a[112:115], v[76:79], v[20:23]
    v_mfma_f32_16x16x32_bf16 a[56:59], a[116:119], v[76:79], a[56:59]
    v_mfma_f32_16x16x32_bf16 a[60:63], a[120:123], v[76:79], a[60:63]
    v_mfma_f32_16x16x32_bf16 a[64:67], a[124:127], v[76:79], a[64:67]
    v_mfma_f32_16x16x32_bf16 v[20:23], a[128:131], v[80:83], v[20:23]
    v_mfma_f32_16x16x32_bf16 a[56:59], a[132:135], v[80:83], a[56:59]
    v_mfma_f32_16x16x32_bf16 a[60:63], a[136:139], v[80:83], a[60:63]
    v_mfma_f32_16x16x32_bf16 a[64:67], a[140:143], v[80:83], a[64:67]
    v_mfma_f32_16x16x32_bf16 v[20:23], a[144:147], v[84:87], v[20:23]
    v_mfma_f32_16x16x32_bf16 a[56:59], a[148:151], v[84:87], a[56:59]
    v_mfma_f32_16x16x32_bf16 a[60:63], a[152:155], v[84:87], a[60:63]
    v_mfma_f32_16x16x32_bf16 a[64:67], a[156:159], v[84:87], a[64:67]
    v_mfma_f32_16x16x32_bf16 v[20:23], a[160:163], v[88:91], v[20:23]
    v_mfma_f32_16x16x32_bf16 a[56:59], a[164:167], v[88:91], a[56:59]
    v_mfma_f32_16x16x32_bf16 a[60:63], a[168:171], v[88:91], a[60:63]
    v_mfma_f32_16x16x32_bf16 a[64:67], a[172:175], v[88:91], a[64:67]
    v_mfma_f32_16x16x32_bf16 v[20:23], a[176:179], v[92:95], v[20:23]
    v_mfma_f32_16x16x32_bf16 a[56:59], a[180:183], v[92:95], a[56:59]
    v_mfma_f32_16x16x32_bf16 a[60:63], a[184:187], v[92:95], a[60:63]
    v_mfma_f32_16x16x32_bf16 a[64:67], a[188:191], v[92:95], a[64:67]
    v_mfma_f32_16x16x32_bf16 v[20:23], a[192:195], v[96:99], v[20:23]
    v_mfma_f32_16x16x32_bf16 a[56:59], a[196:199], v[96:99], a[56:59]
    v_mfma_f32_16x16x32_bf16 a[60:63], a[200:203], v[96:99], a[60:63]
    v_mfma_f32_16x16x32_bf16 a[64:67], a[204:207], v[96:99], a[64:67]
    v_mfma_f32_16x16x32_bf16 v[20:23], a[208:211], v[100:103], v[20:23]
    v_mfma_f32_16x16x32_bf16 a[56:59], a[212:215], v[100:103], a[56:59]
    v_mfma_f32_16x16x32_bf16 a[60:63], a[216:219], v[100:103], a[60:63]
    v_mfma_f32_16x16x32_bf16 a[64:67], a[220:223], v[100:103], a[64:67]
    v_mfma_f32_16x16x32_bf16 v[20:23], a[224:227], v[104:107], v[20:23]
    v_mfma_f32_16x16x32_bf16 a[56:59], a[228:231], v[104:107], a[56:59]
    v_mfma_f32_16x16x32_bf16 a[60:63], a[232:235], v[104:107], a[60:63]
    v_mfma_f32_16x16x32_bf16 a[64:67], a[236:239], v[104:107], a[64:67]
    v_mfma_f32_16x16x32_bf16 v[20:23], a[240:243], v[108:111], v[20:23]
    v_mfma_f32_16x16x32_bf16 a[56:59], a[244:247], v[108:111], a[56:59]
    v_mfma_f32_16x16x32_bf16 a[60:63], a[248:251], v[108:111], a[60:63]
    v_mfma_f32_16x16x32_bf16 a[64:67], a[252:255], v[108:111], a[64:67]
    s_nop 4
    v_cmp_u_f32 vcc, v20, v20
    s_cbranch_vccnz L_rf3
L_last:
    s_branch L_bf3
.section .rodata,"a"
.p2align 6
.amdhsa_kernel sequential_preLN__ssm_conv_s4d__dense_activation_silu__prompt_kernel
  .amdhsa_next_free_vgpr 512
  .amdhsa_next_free_sgpr 102
  .amdhsa_accum_offset 256
  .amdhsa_group_segment_fixed_size 0
  .amdhsa_kernarg_size 104
  .amdhsa_user_sgpr_count 2
  .amdhsa_user_sgpr_kernarg_segment_ptr 1
  .amdhsa_system_sgpr_workgroup_id_x 1
.end_amdhsa_kernel
```
